```python
import torch

def _softmax(x, axis=-1):
    return torch.softmax(x, dim=axis)
def _gelu(x):
    return torch.nn.functional.gelu(x, approximate="tanh")
def _silu(x):
    return torch.nn.functional.silu(x)
def _sigmoid(x):
    return torch.sigmoid(x)
def _layernorm(x, axis=-1, eps=1e-5):
    m = x.mean(dim=axis, keepdim=True)
    v = x.var(dim=axis, keepdim=True, unbiased=False)
    return (x - m) / torch.sqrt(v + eps)
def _scatter_add(tgt, idx, src, axis=0):
    return tgt.clone().index_add_(axis, idx, src)
def _segment_sum(src, seg, n):
    out = torch.zeros((n,) + src.shape[1:], dtype=src.dtype)
    return out.index_add_(0, seg, src)
def _pad(x, pw):
    flat = tuple(v for pair in reversed(pw) for v in pair)
    return torch.nn.functional.pad(x, flat)

kernel_name = 'sequential_preLN__linear_attn_block__geglu_ffn__prompt'

def setup_inputs():

    _w = (lambda a: (lambda t: t.to(torch.bfloat16) if t.is_floating_point() else t)(torch.as_tensor(a)))
    def _A_setup():
        B, S, D = 1, 2048, 1024
        return {
            "x": _w((lambda *s: torch.randn(*s, dtype=torch.bfloat16) * 0.05)(B, S, D)),
            "wqkv": _w((lambda *s: torch.randn(*s, dtype=torch.bfloat16) * 0.05)(D, 3 * D)),
            "wo": _w((lambda *s: torch.randn(*s, dtype=torch.bfloat16) * 0.05)(D, D)),
        }
    _A_in = _A_setup()

    def _B_setup():
        B, S, D, F = 1, 2048, 1024, 3584
        return {
            "x": _w((lambda *s: torch.randn(*s, dtype=torch.bfloat16) * 0.05)(B, S, D)),
            "w_gate": _w((lambda *s: torch.randn(*s, dtype=torch.bfloat16) * 0.05)(D, F)),
            "w_up": _w((lambda *s: torch.randn(*s, dtype=torch.bfloat16) * 0.05)(D, F)),
            "w_down": _w((lambda *s: torch.randn(*s, dtype=torch.bfloat16) * 0.05)(F, D)),
        }
    _B_in = _B_setup()

    return {
        "A_x": _A_in["x"],
        "A_wqkv": _A_in["wqkv"],
        "A_wo": _A_in["wo"],
        "B_x": _B_in["x"],
        "B_w_gate": _B_in["w_gate"],
        "B_w_up": _B_in["w_up"],
        "B_w_down": _B_in["w_down"],
    }

def reference(A_x, A_wqkv, A_wo, B_x, B_w_gate, B_w_up, B_w_down):
    def _A_ref(x, wqkv, wo):
        B, S, D = x.shape
        H = 32; Dh = D // H
        qkv = (lambda x, *d: x.permute(*d))((x @ wqkv).reshape(B, S, 3, H, Dh), 2, 0, 3, 1, 4)
        q, k, v = qkv[0], qkv[1], qkv[2]
        phi = lambda t: torch.where(t > 0, t + 1, torch.exp(t)) + 1e-6
        pq, pk = phi(q), phi(k)
        kv = torch.einsum("bhsd,bhse->bhde", pk, v)
        z = torch.einsum("bhsd->bhd", pk)
        num = torch.einsum("bhqd,bhde->bhqe", pq, kv)
        den = torch.einsum("bhqd,bhd->bhq", pq, z)[..., None] + 1e-6
        o = num / den
        return (lambda x, *d: x.permute(*d))(o, 0, 2, 1, 3).reshape(B, S, D) @ wo

    def _B_ref(x, w_gate, w_up, w_down):
        return (_gelu(x @ w_gate) * (x @ w_up)) @ w_down

    x = A_x
    h = x + _A_ref(_layernorm(x, axis=-1), A_wqkv, A_wo)
    h2 = h + _B_ref(_layernorm(h, axis=-1), B_w_gate, B_w_up, B_w_down)
    return h2
```

```asm
; @launch kernel=gemm1_kernel grid=(256,1,1) block=(512,1,1) lds=163840
; @launch kernel=attn_kernel grid=(256,1,1) block=(256,1,1) lds=24576
; @launch kernel=gemm2_kernel grid=(256,1,1) block=(512,1,1) lds=65536
; @launch kernel=gemm3_kernel grid=(256,1,1) block=(512,1,1) lds=147456
; @launch kernel=gemm4_kernel grid=(256,1,1) block=(512,1,1) lds=49152
.amdgcn_target "amdgcn-amd-amdhsa--gfx950"
.text
.globl gemm1_kernel
.p2align 8
.type gemm1_kernel,@function
gemm1_kernel:
  s_cmp_ge_u32 s2, 256
  s_cbranch_scc1 L_gemm1_kernel_end
  s_load_dwordx16 s[64:79], s[0:1], 0
  s_load_dwordx4 s[80:83], s[0:1], 64
  v_lshrrev_b32 v127, 6, v0
  v_and_b32 v124, 63, v0
  s_nop 0
  v_readfirstlane_b32 s20, v127
  s_cmp_lg_u32 s20, 3
  s_cbranch_scc1 L_nocpf
  s_getpc_b64 s[12:13]
L_cpf_pc:
  s_lshr_b32 s28, s2, 3
  s_lshl_b32 s28, s28, 13
  v_lshlrev_b32 v130, 7, v124
  v_add_u32 v130, s28, v130
  v_cmp_gt_u32 vcc, L_text_end-L_cpf_pc, v130
  s_and_b64 exec, exec, vcc
  s_cbranch_execz L_cpf_x
  global_load_dword v131, v130, s[12:13]
L_cpf_x:
  s_mov_b64 exec, -1
L_nocpf:
  s_and_b32 s21, s2, 7
  s_lshr_b32 s22, s2, 3
  s_and_b32 s23, s21, 1
  s_lshr_b32 s24, s21, 1
  s_and_b32 s26, s22, 3
  s_lshr_b32 s25, s22, 2
  s_mul_i32 s23, s23, 8
  s_add_u32 s17, s23, s25
  s_mul_i32 s24, s24, 4
  s_add_u32 s16, s24, s26
  v_lshlrev_b32 v125, 4, v124
  v_mov_b32 v112, 0x3f803f80
  v_mov_b32 v113, 0x3f803f80
  v_mov_b32 v114, 0x3f803f80
  v_mov_b32 v115, 0x3f803f80
  v_lshrrev_b32 v127, 3, v124
  v_and_b32 v128, 7, v124
  v_xor_b32 v128, v128, v127
  v_lshlrev_b32 v127, 11, v127
  v_lshl_add_u32 v116, v128, 4, v127
  v_add_u32 v117, 16384, v116
  v_add_u32 v118, 32768, v116
  v_add_u32 v119, 49152, v116
  v_and_b32 v127, 15, v124
  v_lshrrev_b32 v128, 4, v124
  v_and_b32 v129, 7, v124
  v_xor_b32 v128, v128, v129
  v_lshlrev_b32 v127, 7, v127
  v_lshl_add_u32 v127, v128, 4, v127
  s_lshl_b32 s28, s20, 12
  s_add_u32 s28, s28, 24576
  v_add_u32 v120, s28, v127
  v_xor_b32 v121, 64, v120
  v_lshrrev_b32 v127, 5, v124
  v_mul_u32_u24 v126, 6144, v127
  v_bfe_u32 v128, v124, 2, 3
  v_lshl_add_u32 v126, v128, 7, v126
  v_lshrrev_b32 v128, 1, v128
  v_lshl_add_u32 v126, v128, 5, v126
  v_and_b32 v127, 3, v124
  v_lshl_add_u32 v126, v127, 3, v126
  s_sub_u32 s19, s20, 4
  s_max_i32 s19, s19, 0
  s_min_i32 s19, s19, 3
  s_mul_i32 s27, s19, 6
  v_lshrrev_b32 v129, 4, v124
  v_bfe_u32 v128, v124, 1, 2
  v_xor_b32 v128, v128, v129
  v_lshrrev_b32 v127, 5, v124
  v_mul_u32_u24 v127, 8, v127
  v_bfe_u32 v129, v124, 3, 2
  v_add_u32 v127, v127, v129
  v_mul_u32_u24 v127, 6144, v127
  v_lshl_add_u32 v127, v128, 5, v127
  v_and_b32 v129, 1, v124
  v_lshl_add_u32 v127, v129, 4, v127
  s_lshr_b32 s30, s19, 1
  s_mul_i32 s30, s30, 196608
  s_and_b32 s31, s19, 1
  s_mul_i32 s31, s31, 98304
  s_add_u32 s30, s30, s31
  v_add_u32 v140, s30, v127
  v_add_u32 v141, 2048, v140
  v_add_u32 v142, 4096, v140
  v_add_u32 v143, 24576, v140
  v_add_u32 v144, 26624, v140
  v_add_u32 v145, 28672, v140
  s_waitcnt lgkmcnt(0)
  s_mov_b32 s8, s64
  s_mov_b32 s9, s65
  s_mov_b32 s10, 4194304
  s_mov_b32 s11, 0x20000
  s_add_u32 s28, s27, 0
  s_mov_b32 s40, s66
  s_mov_b32 s41, s67
  s_cmp_ge_u32 s28, 24
  s_cselect_b32 s42, 0, 6291456
  s_mov_b32 s43, 0x20000
  s_mul_i32 s32, s16, 8
  s_mul_i32 s28, s20, 2
  s_add_u32 s18, s32, s28
  s_lshl_b32 s32, s18, 10
  s_mul_i32 s32, s16, 8
  s_lshl_b32 s28, s19, 1
  s_add_u32 s32, s32, s28
  s_lshl_b32 s32, s32, 15
  s_lshl_b32 s60, s19, 12
  s_add_u32 s60, s60, 24576
  s_mul_i32 s33, s17, 128
  s_lshl_b32 s39, s27, 10
  s_mov_b32 s37, 0
  s_mov_b32 s35, 0
  s_mov_b32 s38, 0x7ff00000
  s_cmp_lt_u32 s20, 4
  s_cbranch_scc1 L_gemm1_kernel_comp
  s_lshr_b32 s54, s17, 3
  s_mul_i32 s54, s54, 8
  s_lshr_b32 s55, s16, 2
  s_mul_i32 s55, s55, 8
  s_add_u32 s54, s54, s55
  s_and_b32 s54, s54, 15
  s_lshl_b32 s55, s54, 7
  s_add_u32 s32, s32, s55
  s_mul_i32 s55, s54, 393216
  s_add_u32 s33, s33, s55
  s_lshl_b32 s28, s19, 5
  v_xor_b32 v126, s28, v126
  v_mov_b32 v0, 0
  v_mov_b32 v1, 0
  v_mov_b32 v2, 0
  v_mov_b32 v3, 0
  v_mov_b32 v4, 0
  v_mov_b32 v5, 0
  v_mov_b32 v6, 0
  v_mov_b32 v7, 0
  v_mov_b32 v8, 0
  v_mov_b32 v9, 0
  v_mov_b32 v10, 0
  v_mov_b32 v11, 0
  s_add_u32 s61, s37, s60
  s_add_u32 s36, s37, s39
  s_add_u32 s37, s37, 40960
  s_cmp_eq_u32 s37, 163840
  s_cselect_b32 s37, 0, s37
  s_add_u32 m0, s61, 0
  s_nop 0
  buffer_load_dwordx4 v116, s[8:11], s32 offen lds
  s_add_u32 m0, s61, 1024
  s_nop 0
  buffer_load_dwordx4 v117, s[8:11], s32 offen lds
  s_add_u32 m0, s61, 2048
  s_nop 0
  buffer_load_dwordx4 v118, s[8:11], s32 offen lds
  s_add_u32 m0, s61, 3072
  s_nop 0
  buffer_load_dwordx4 v119, s[8:11], s32 offen lds
  s_add_u32 s32, s32, 128
  s_and_b32 s55, s32, 2047
  s_cselect_b32 s55, 0, 2048
  s_sub_u32 s32, s32, s55
  s_add_u32 m0, s36, 0
  s_nop 0
  buffer_load_dwordx4 v140, s[40:43], s33 offen lds
  s_add_u32 m0, s36, 1024
  s_nop 0
  buffer_load_dwordx4 v141, s[40:43], s33 offen lds
  s_add_u32 m0, s36, 2048
  s_nop 0
  buffer_load_dwordx4 v142, s[40:43], s33 offen lds
  s_add_u32 m0, s36, 3072
  s_nop 0
  buffer_load_dwordx4 v143, s[40:43], s33 offen lds
  s_add_u32 m0, s36, 4096
  s_nop 0
  buffer_load_dwordx4 v144, s[40:43], s33 offen lds
  s_add_u32 m0, s36, 5120
  s_nop 0
  buffer_load_dwordx4 v145, s[40:43], s33 offen lds
  s_add_u32 s33, s33, 393216
  s_cmp_ge_u32 s33, 6291456
  s_cselect_b32 s55, 6291456, 0
  s_sub_u32 s33, s33, s55
  s_add_u32 s61, s37, s60
  s_add_u32 s36, s37, s39
  s_add_u32 s37, s37, 40960
  s_cmp_eq_u32 s37, 163840
  s_cselect_b32 s37, 0, s37
  s_add_u32 m0, s61, 0
  s_nop 0
  buffer_load_dwordx4 v116, s[8:11], s32 offen lds
  s_add_u32 m0, s61, 1024
  s_nop 0
  buffer_load_dwordx4 v117, s[8:11], s32 offen lds
  s_add_u32 m0, s61, 2048
  s_nop 0
  buffer_load_dwordx4 v118, s[8:11], s32 offen lds
  s_add_u32 m0, s61, 3072
  s_nop 0
  buffer_load_dwordx4 v119, s[8:11], s32 offen lds
  s_add_u32 s32, s32, 128
  s_and_b32 s55, s32, 2047
  s_cselect_b32 s55, 0, 2048
  s_sub_u32 s32, s32, s55
  s_add_u32 m0, s36, 0
  s_nop 0
  buffer_load_dwordx4 v140, s[40:43], s33 offen lds
  s_add_u32 m0, s36, 1024
  s_nop 0
  buffer_load_dwordx4 v141, s[40:43], s33 offen lds
  s_add_u32 m0, s36, 2048
  s_nop 0
  buffer_load_dwordx4 v142, s[40:43], s33 offen lds
  s_add_u32 m0, s36, 3072
  s_nop 0
  buffer_load_dwordx4 v143, s[40:43], s33 offen lds
  s_add_u32 m0, s36, 4096
  s_nop 0
  buffer_load_dwordx4 v144, s[40:43], s33 offen lds
  s_add_u32 m0, s36, 5120
  s_nop 0
  buffer_load_dwordx4 v145, s[40:43], s33 offen lds
  s_add_u32 s33, s33, 393216
  s_cmp_ge_u32 s33, 6291456
  s_cselect_b32 s55, 6291456, 0
  s_sub_u32 s33, s33, s55
  s_waitcnt vmcnt(10)
  s_barrier
  v_add_u32 v132, s35, v126
  s_add_u32 s35, s35, 40960
  s_cmp_eq_u32 s35, 163840
  s_cselect_b32 s35, 0, s35
  ds_read_b64_tr_b16 v[148:149], v132 offset:0
  ds_read_b64_tr_b16 v[150:151], v132 offset:3072
  ds_read_b64_tr_b16 v[152:153], v132 offset:1024
  ds_read_b64_tr_b16 v[154:155], v132 offset:4096
  ds_read_b64_tr_b16 v[156:157], v132 offset:2048
  ds_read_b64_tr_b16 v[158:159], v132 offset:5120
  ds_read_b64_tr_b16 v[160:161], v132 offset:12288
  ds_read_b64_tr_b16 v[162:163], v132 offset:15360
  ds_read_b64_tr_b16 v[164:165], v132 offset:13312
  ds_read_b64_tr_b16 v[166:167], v132 offset:16384
  ds_read_b64_tr_b16 v[168:169], v132 offset:14336
  ds_read_b64_tr_b16 v[170:171], v132 offset:17408
  s_add_u32 s61, s37, s60
  s_add_u32 s36, s37, s39
  s_add_u32 s37, s37, 40960
  s_cmp_eq_u32 s37, 163840
  s_cselect_b32 s37, 0, s37
  s_add_u32 m0, s61, 0
  s_nop 0
  buffer_load_dwordx4 v116, s[8:11], s32 offen lds
  s_add_u32 m0, s61, 1024
  s_nop 0
  buffer_load_dwordx4 v117, s[8:11], s32 offen lds
  s_add_u32 m0, s61, 2048
  s_nop 0
  buffer_load_dwordx4 v118, s[8:11], s32 offen lds
  s_waitcnt lgkmcnt(10)
  v_mfma_f32_16x16x32_bf16 v[0:3], v[148:151], v[112:115], v[0:3]
  s_add_u32 m0, s61, 3072
  s_nop 0
  buffer_load_dwordx4 v119, s[8:11], s32 offen lds
  s_waitcnt lgkmcnt(8)
  v_mfma_f32_16x16x32_bf16 v[4:7], v[152:155], v[112:115], v[4:7]
  s_add_u32 s32, s32, 128
  s_and_b32 s55, s32, 2047
  s_cselect_b32 s55, 0, 2048
  s_sub_u32 s32, s32, s55
  s_add_u32 m0, s36, 0
  s_nop 0
  buffer_load_dwordx4 v140, s[40:43], s33 offen lds
  s_waitcnt lgkmcnt(6)
  v_mfma_f32_16x16x32_bf16 v[8:11], v[156:159], v[112:115], v[8:11]
  s_add_u32 m0, s36, 1024
  s_nop 0
  buffer_load_dwordx4 v141, s[40:43], s33 offen lds
  s_waitcnt lgkmcnt(4)
  v_mfma_f32_16x16x32_bf16 v[0:3], v[160:163], v[112:115], v[0:3]
  s_add_u32 m0, s36, 2048
  s_nop 0
  buffer_load_dwordx4 v142, s[40:43], s33 offen lds
  s_waitcnt lgkmcnt(2)
  v_mfma_f32_16x16x32_bf16 v[4:7], v[164:167], v[112:115], v[4:7]
  s_add_u32 m0, s36, 3072
  s_nop 0
  buffer_load_dwordx4 v143, s[40:43], s33 offen lds
  s_waitcnt lgkmcnt(0)
  v_mfma_f32_16x16x32_bf16 v[8:11], v[168:171], v[112:115], v[8:11]
  s_add_u32 m0, s36, 4096
  s_nop 0
  buffer_load_dwordx4 v144, s[40:43], s33 offen lds
  s_add_u32 m0, s36, 5120
  s_nop 0
  buffer_load_dwordx4 v145, s[40:43], s33 offen lds
  s_add_u32 s33, s33, 393216
  s_cmp_ge_u32 s33, 6291456
  s_cselect_b32 s55, 6291456, 0
  s_sub_u32 s33, s33, s55
  s_mov_b32 s34, 13
L_gemm1_kernel_lloop:
  s_waitcnt vmcnt(10)
  s_barrier
  v_add_u32 v132, s35, v126
  s_add_u32 s35, s35, 40960
  s_cmp_eq_u32 s35, 163840
  s_cselect_b32 s35, 0, s35
  ds_read_b64_tr_b16 v[148:149], v132 offset:0
  ds_read_b64_tr_b16 v[150:151], v132 offset:3072
  ds_read_b64_tr_b16 v[152:153], v132 offset:1024
  ds_read_b64_tr_b16 v[154:155], v132 offset:4096
  ds_read_b64_tr_b16 v[156:157], v132 offset:2048
  ds_read_b64_tr_b16 v[158:159], v132 offset:5120
  ds_read_b64_tr_b16 v[160:161], v132 offset:12288
  ds_read_b64_tr_b16 v[162:163], v132 offset:15360
  ds_read_b64_tr_b16 v[164:165], v132 offset:13312
  ds_read_b64_tr_b16 v[166:167], v132 offset:16384
  ds_read_b64_tr_b16 v[168:169], v132 offset:14336
  ds_read_b64_tr_b16 v[170:171], v132 offset:17408
  s_add_u32 s61, s37, s60
  s_add_u32 s36, s37, s39
  s_add_u32 s37, s37, 40960
  s_cmp_eq_u32 s37, 163840
  s_cselect_b32 s37, 0, s37
  s_add_u32 m0, s61, 0
  s_nop 0
  buffer_load_dwordx4 v116, s[8:11], s32 offen lds
  s_add_u32 m0, s61, 1024
  s_nop 0
  buffer_load_dwordx4 v117, s[8:11], s32 offen lds
  s_add_u32 m0, s61, 2048
  s_nop 0
  buffer_load_dwordx4 v118, s[8:11], s32 offen lds
  s_waitcnt lgkmcnt(10)
  v_mfma_f32_16x16x32_bf16 v[0:3], v[148:151], v[112:115], v[0:3]
  s_add_u32 m0, s61, 3072
  s_nop 0
  buffer_load_dwordx4 v119, s[8:11], s32 offen lds
  s_waitcnt lgkmcnt(8)
  v_mfma_f32_16x16x32_bf16 v[4:7], v[152:155], v[112:115], v[4:7]
  s_add_u32 s32, s32, 128
  s_and_b32 s55, s32, 2047
  s_cselect_b32 s55, 0, 2048
  s_sub_u32 s32, s32, s55
  s_add_u32 m0, s36, 0
  s_nop 0
  buffer_load_dwordx4 v140, s[40:43], s33 offen lds
  s_waitcnt lgkmcnt(6)
  v_mfma_f32_16x16x32_bf16 v[8:11], v[156:159], v[112:115], v[8:11]
  s_add_u32 m0, s36, 1024
  s_nop 0
  buffer_load_dwordx4 v141, s[40:43], s33 offen lds
  s_waitcnt lgkmcnt(4)
  v_mfma_f32_16x16x32_bf16 v[0:3], v[160:163], v[112:115], v[0:3]
  s_add_u32 m0, s36, 2048
  s_nop 0
  buffer_load_dwordx4 v142, s[40:43], s33 offen lds
  s_waitcnt lgkmcnt(2)
  v_mfma_f32_16x16x32_bf16 v[4:7], v[164:167], v[112:115], v[4:7]
  s_add_u32 m0, s36, 3072
  s_nop 0
  buffer_load_dwordx4 v143, s[40:43], s33 offen lds
  s_waitcnt lgkmcnt(0)
  v_mfma_f32_16x16x32_bf16 v[8:11], v[168:171], v[112:115], v[8:11]
  s_add_u32 m0, s36, 4096
  s_nop 0
  buffer_load_dwordx4 v144, s[40:43], s33 offen lds
  s_add_u32 m0, s36, 5120
  s_nop 0
  buffer_load_dwordx4 v145, s[40:43], s33 offen lds
  s_add_u32 s33, s33, 393216
  s_cmp_ge_u32 s33, 6291456
  s_cselect_b32 s55, 6291456, 0
  s_sub_u32 s33, s33, s55
  s_sub_u32 s34, s34, 1
  s_cmp_lg_u32 s34, 0
  s_cbranch_scc1 L_gemm1_kernel_lloop
  s_lshr_b32 s28, s2, 3
  s_cmp_ge_u32 s28, 12
  s_cselect_b32 s29, 4, 0
  s_lshr_b32 s30, s28, 2
  s_sub_u32 s28, s28, s29
  s_cmp_eq_u32 s30, 3
  s_cselect_b32 s28, 28, s28
  s_cmp_ge_u32 s28, 28
  s_cselect_b32 s6, 0, 7340032
  s_cselect_b32 s63, 1, 0
  s_mov_b32 s7, 0x20000
  s_lshl_b32 s28, s28, 3
  s_and_b32 s29, s2, 7
  s_add_u32 s28, s28, s29
  s_mul_i32 s29, s28, 4682
  s_lshr_b32 s29, s29, 16
  s_mul_i32 s30, s29, 14
  s_sub_u32 s28, s28, s30
  s_mul_i32 s62, s29, 28672
  s_lshl_b32 s30, s28, 11
  s_add_u32 s62, s62, s30
  s_lshl_b32 s28, s2, 2
  s_add_u32 s28, s28, s19
  v_lshlrev_b32 v130, 7, v124
  s_mov_b32 s44, s68
  s_mov_b32 s45, s69
  s_mov_b32 s46, 2097152
  s_mov_b32 s47, 0x20000
  s_mul_i32 s29, s28, 2048
  s_mov_b32 exec_lo, 65535
  s_mov_b32 exec_hi, 0
  buffer_load_dword v129, v130, s[44:47], s29 offen
  s_mov_b32 s44, s76
  s_mov_b32 s45, s77
  s_mov_b32 s46, 3670016
  s_mov_b32 s47, 0x20000
  s_mul_i32 s29, s28, 3584
  s_mov_b32 exec_lo, 268435455
  s_mov_b32 exec_hi, 0
  buffer_load_dword v129, v130, s[44:47], s29 offen
  s_mov_b64 exec, -1
  s_waitcnt vmcnt(12)
  s_barrier
  v_add_u32 v132, s35, v126
  s_add_u32 s35, s35, 40960
  s_cmp_eq_u32 s35, 163840
  s_cselect_b32 s35, 0, s35
  ds_read_b64_tr_b16 v[148:149], v132 offset:0
  ds_read_b64_tr_b16 v[150:151], v132 offset:3072
  ds_read_b64_tr_b16 v[152:153], v132 offset:1024
  ds_read_b64_tr_b16 v[154:155], v132 offset:4096
  ds_read_b64_tr_b16 v[156:157], v132 offset:2048
  ds_read_b64_tr_b16 v[158:159], v132 offset:5120
  ds_read_b64_tr_b16 v[160:161], v132 offset:12288
  ds_read_b64_tr_b16 v[162:163], v132 offset:15360
  ds_read_b64_tr_b16 v[164:165], v132 offset:13312
  ds_read_b64_tr_b16 v[166:167], v132 offset:16384
  ds_read_b64_tr_b16 v[168:169], v132 offset:14336
  ds_read_b64_tr_b16 v[170:171], v132 offset:17408
  s_waitcnt lgkmcnt(10)
  v_mfma_f32_16x16x32_bf16 v[0:3], v[148:151], v[112:115], v[0:3]
  s_waitcnt lgkmcnt(8)
  v_mfma_f32_16x16x32_bf16 v[4:7], v[152:155], v[112:115], v[4:7]
  s_waitcnt lgkmcnt(6)
  v_mfma_f32_16x16x32_bf16 v[8:11], v[156:159], v[112:115], v[8:11]
  s_waitcnt lgkmcnt(4)
  v_mfma_f32_16x16x32_bf16 v[0:3], v[160:163], v[112:115], v[0:3]
  s_waitcnt lgkmcnt(2)
  v_mfma_f32_16x16x32_bf16 v[4:7], v[164:167], v[112:115], v[4:7]
  s_waitcnt lgkmcnt(0)
  v_mfma_f32_16x16x32_bf16 v[8:11], v[168:171], v[112:115], v[8:11]
  s_waitcnt vmcnt(2)
  s_barrier
  v_add_u32 v132, s35, v126
  s_add_u32 s35, s35, 40960
  s_cmp_eq_u32 s35, 163840
  s_cselect_b32 s35, 0, s35
  ds_read_b64_tr_b16 v[148:149], v132 offset:0
  ds_read_b64_tr_b16 v[150:151], v132 offset:3072
  ds_read_b64_tr_b16 v[152:153], v132 offset:1024
  ds_read_b64_tr_b16 v[154:155], v132 offset:4096
  ds_read_b64_tr_b16 v[156:157], v132 offset:2048
  ds_read_b64_tr_b16 v[158:159], v132 offset:5120
  ds_read_b64_tr_b16 v[160:161], v132 offset:12288
  ds_read_b64_tr_b16 v[162:163], v132 offset:15360
  ds_read_b64_tr_b16 v[164:165], v132 offset:13312
  ds_read_b64_tr_b16 v[166:167], v132 offset:16384
  ds_read_b64_tr_b16 v[168:169], v132 offset:14336
  ds_read_b64_tr_b16 v[170:171], v132 offset:17408
  s_waitcnt lgkmcnt(10)
  v_mfma_f32_16x16x32_bf16 v[0:3], v[148:151], v[112:115], v[0:3]
  s_waitcnt lgkmcnt(8)
  v_mfma_f32_16x16x32_bf16 v[4:7], v[152:155], v[112:115], v[4:7]
  s_waitcnt lgkmcnt(6)
  v_mfma_f32_16x16x32_bf16 v[8:11], v[156:159], v[112:115], v[8:11]
  s_waitcnt lgkmcnt(4)
  v_mfma_f32_16x16x32_bf16 v[0:3], v[160:163], v[112:115], v[0:3]
  s_waitcnt lgkmcnt(2)
  v_mfma_f32_16x16x32_bf16 v[4:7], v[164:167], v[112:115], v[4:7]
  s_waitcnt lgkmcnt(0)
  v_mfma_f32_16x16x32_bf16 v[8:11], v[168:171], v[112:115], v[8:11]
  s_barrier
  s_waitcnt lgkmcnt(0)
  s_nop 7
  s_nop 7
  s_lshl_b32 s28, s19, 6
  s_add_u32 s28, s28, 65536
  v_lshrrev_b32 v127, 4, v124
  v_lshlrev_b32 v127, 4, v127
  v_add_u32 v127, s28, v127
  ds_write_b128 v127, v[0:3] offset:0
  ds_write_b128 v127, v[4:7] offset:256
  ds_write_b128 v127, v[8:11] offset:512
  s_waitcnt lgkmcnt(0)
  s_barrier
  s_cmp_lg_u32 s63, 0
  s_cbranch_scc1 L_gemm1_kernel_nocs
  v_lshrrev_b32 v127, 5, v124
  v_lshlrev_b32 v127, 8, v127
  v_and_b32 v128, 7, v124
  v_lshl_add_u32 v127, v128, 4, v127
  v_bfe_u32 v128, v124, 3, 2
  v_lshl_add_u32 v127, v128, 2, v127
  s_lshl_b32 s28, s19, 10
  s_add_u32 s28, s28, 69632
  v_add_u32 v127, s28, v127
  ds_read_b32 v0, v127 offset:0
  ds_read_b32 v1, v127 offset:512
  ds_read_b32 v2, v127 offset:4096
  ds_read_b32 v3, v127 offset:4608
  ds_read_b32 v4, v127 offset:8192
  ds_read_b32 v5, v127 offset:8704
  ds_read_b32 v6, v127 offset:12288
  ds_read_b32 v7, v127 offset:12800
  s_add_u32 s4, s82, 22020096
  s_addc_u32 s5, s83, 0
  s_mov_b32 s6, 1048576
  s_mov_b32 s7, 0x20000
  s_lshl_b32 s28, s19, 9
  s_add_u32 s62, s62, s28
  v_lshlrev_b32 v128, 2, v124
  s_waitcnt lgkmcnt(0)
  v_add_f32 v0, v0, v2
  v_add_f32 v1, v1, v3
  v_add_f32 v0, v0, v4
  v_add_f32 v1, v1, v5
  v_add_f32 v0, v0, v6
  v_add_f32 v1, v1, v7
  buffer_store_dword v0, v128, s[4:7], s62 offen sc0 sc1
  buffer_store_dword v1, v128, s[4:7], s62 offen offset:256 sc0 sc1
L_gemm1_kernel_nocs:
  s_barrier
  s_branch L_gemm1_kernel_end
L_gemm1_kernel_comp:
  s_cmp_ge_u32 s20, 4
  s_cbranch_scc1 L_gemm1_kernel_noearly
  s_lshl_b32 s28, s2, 2
  s_add_u32 s28, s28, s20
  s_lshl_b32 s28, s28, 13
  v_lshlrev_b32 v130, 7, v124
  v_add_u32 v130, s28, v130
  v_lshlrev_b32 v130, 10, v124
  s_cmp_lg_u32 s20, 0
  s_cbranch_scc1 L_gemm1_kernel_e0
  s_mov_b32 s44, s66
  s_mov_b32 s45, s67
  s_mov_b32 s46, 6291456
  s_mov_b32 s47, 0x20000
  s_mul_i32 s29, s2, 24576
  s_mov_b32 exec_lo, 16777215
  s_mov_b32 exec_hi, 0
  buffer_load_dword v129, v130, s[44:47], s29 offen offset:384
  s_mov_b64 exec, -1
L_gemm1_kernel_e0:
L_gemm1_kernel_noearly:
  s_lshr_b32 s28, s2, 3
  s_cmp_ge_u32 s28, 12
  s_cselect_b32 s29, 4, 0
  s_lshr_b32 s30, s28, 2
  s_sub_u32 s28, s28, s29
  s_cmp_eq_u32 s30, 3
  s_cselect_b32 s28, 28, s28
  s_cmp_ge_u32 s28, 28
  s_cselect_b32 s6, 0, 7340032
  s_cselect_b32 s63, 1, 0
  s_mov_b32 s7, 0x20000
  s_lshl_b32 s28, s28, 3
  s_and_b32 s29, s2, 7
  s_add_u32 s28, s28, s29
  s_mul_i32 s29, s28, 4682
  s_lshr_b32 s29, s29, 16
  s_mul_i32 s30, s29, 14
  s_sub_u32 s28, s28, s30
  s_mul_i32 s62, s29, 28672
  s_lshl_b32 s30, s28, 11
  s_add_u32 s62, s62, s30
  s_cmp_ge_u32 s28, 7
  s_cselect_b32 s4, s74, s72
  s_cselect_b32 s5, s75, s73
  s_cselect_b32 s30, 7, 0
  s_sub_u32 s28, s28, s30
  s_lshl_b32 s29, s29, 2
  s_add_u32 s29, s29, s20
  s_mul_i32 s29, s29, 114688
  s_lshl_b32 s28, s28, 10
  s_add_u32 s3, s29, s28
  v_mov_b32 v228, 0
  v_mov_b32 v229, 0
  v_mov_b32 v230, 0
  v_mov_b32 v231, 0
  v_mov_b32 v232, 0
  v_mov_b32 v233, 0
  v_mov_b32 v234, 0
  v_mov_b32 v235, 0
  v_mov_b32 v236, 0
  v_mov_b32 v237, 0
  v_mov_b32 v238, 0
  v_mov_b32 v239, 0
  v_mov_b32 v240, 0
  v_mov_b32 v241, 0
  v_mov_b32 v242, 0
  v_mov_b32 v243, 0
  v_and_b32 v127, 1, v124
  v_lshlrev_b32 v127, 4, v127
  v_mov_b32 v128, 0x3f80
  v_lshlrev_b32 v127, v127, v128
  v_bfe_u32 v128, v124, 1, 3
  v_cmp_eq_u32 vcc, 0, v128
  v_cndmask_b32 v244, 0, v127, vcc
  v_cmp_eq_u32 vcc, 1, v128
  v_cndmask_b32 v245, 0, v127, vcc
  v_cmp_eq_u32 vcc, 2, v128
  v_cndmask_b32 v246, 0, v127, vcc
  v_cmp_eq_u32 vcc, 3, v128
  v_cndmask_b32 v247, 0, v127, vcc
  v_lshrrev_b32 v127, 4, v124
  v_mul_u32_u24 v127, 7168, v127
  v_and_b32 v128, 15, v124
  v_lshl_add_u32 v248, v128, 4, v127
  s_lshl_b32 s28, s20, 8
  s_add_u32 s28, s28, s2
  s_mov_b32 s44, s68
  s_mov_b32 s45, s69
  s_mov_b32 s46, 2097152
  s_mov_b32 s47, 0x20000
  s_add_u32 s48, s82, 23068672
  s_addc_u32 s49, s83, 0
  s_mov_b32 s50, 262144
  s_mov_b32 s51, 0x20000
  s_cmp_ge_u32 s28, 256
  s_cselect_b32 s46, 0, s46
  s_cselect_b32 s50, 0, s50
  s_lshl_b32 s53, s28, 10
  s_cmp_ge_u32 s28, 128
  s_cselect_b32 s30, 128, 0
  s_cselect_b32 s29, 1408, 0
  s_sub_u32 s28, s28, s30
  s_max_u32 s29, s29, 384
  s_lshl_b32 s52, s28, 14
  s_add_u32 s52, s52, s29
  v_lshrrev_b32 v127, 3, v124
  v_lshlrev_b32 v127, 11, v127
  v_and_b32 v249, 7, v124
  v_lshl_add_u32 v249, v249, 4, v127
  v_mov_b32 v0, 0
  v_mov_b32 v1, 0
  v_mov_b32 v2, 0
  v_mov_b32 v3, 0
  v_mov_b32 v4, 0
  v_mov_b32 v5, 0
  v_mov_b32 v6, 0
  v_mov_b32 v7, 0
  v_mov_b32 v8, 0
  v_mov_b32 v9, 0
  v_mov_b32 v10, 0
  v_mov_b32 v11, 0
  v_mov_b32 v12, 0
  v_mov_b32 v13, 0
  v_mov_b32 v14, 0
  v_mov_b32 v15, 0
  v_mov_b32 v16, 0
  v_mov_b32 v17, 0
  v_mov_b32 v18, 0
  v_mov_b32 v19, 0
  v_mov_b32 v20, 0
  v_mov_b32 v21, 0
  v_mov_b32 v22, 0
  v_mov_b32 v23, 0
  v_mov_b32 v24, 0
  v_mov_b32 v25, 0
  v_mov_b32 v26, 0
  v_mov_b32 v27, 0
  v_mov_b32 v28, 0
  v_mov_b32 v29, 0
  v_mov_b32 v30, 0
  v_mov_b32 v31, 0
  v_mov_b32 v32, 0
  v_mov_b32 v33, 0
  v_mov_b32 v34, 0
  v_mov_b32 v35, 0
  v_mov_b32 v36, 0
  v_mov_b32 v37, 0
  v_mov_b32 v38, 0
  v_mov_b32 v39, 0
  v_mov_b32 v40, 0
  v_mov_b32 v41, 0
  v_mov_b32 v42, 0
  v_mov_b32 v43, 0
  v_mov_b32 v44, 0
  v_mov_b32 v45, 0
  v_mov_b32 v46, 0
  v_mov_b32 v47, 0
  v_mov_b32 v48, 0
  v_mov_b32 v49, 0
  v_mov_b32 v50, 0
  v_mov_b32 v51, 0
  v_mov_b32 v52, 0
  v_mov_b32 v53, 0
  v_mov_b32 v54, 0
  v_mov_b32 v55, 0
  v_mov_b32 v56, 0
  v_mov_b32 v57, 0
  v_mov_b32 v58, 0
  v_mov_b32 v59, 0
  v_mov_b32 v60, 0
  v_mov_b32 v61, 0
  v_mov_b32 v62, 0
  v_mov_b32 v63, 0
  v_mov_b32 v64, 0
  v_mov_b32 v65, 0
  v_mov_b32 v66, 0
  v_mov_b32 v67, 0
  v_mov_b32 v68, 0
  v_mov_b32 v69, 0
  v_mov_b32 v70, 0
  v_mov_b32 v71, 0
  v_mov_b32 v72, 0
  v_mov_b32 v73, 0
  v_mov_b32 v74, 0
  v_mov_b32 v75, 0
  v_mov_b32 v76, 0
  v_mov_b32 v77, 0
  v_mov_b32 v78, 0
  v_mov_b32 v79, 0
  v_mov_b32 v80, 0
  v_mov_b32 v81, 0
  v_mov_b32 v82, 0
  v_mov_b32 v83, 0
  v_mov_b32 v84, 0
  v_mov_b32 v85, 0
  v_mov_b32 v86, 0
  v_mov_b32 v87, 0
  v_mov_b32 v88, 0
  v_mov_b32 v89, 0
  v_mov_b32 v90, 0
  v_mov_b32 v91, 0
  v_mov_b32 v92, 0
  v_mov_b32 v93, 0
  v_mov_b32 v94, 0
  v_mov_b32 v95, 0
  v_mov_b32 v96, 0
  v_mov_b32 v97, 0
  v_mov_b32 v98, 0
  v_mov_b32 v99, 0
  v_mov_b32 v100, 0
  v_mov_b32 v101, 0
  v_mov_b32 v102, 0
  v_mov_b32 v103, 0
  v_mov_b32 v104, 0
  v_mov_b32 v105, 0
  v_mov_b32 v106, 0
  v_mov_b32 v107, 0
  v_mov_b32 v108, 0
  v_mov_b32 v109, 0
  v_mov_b32 v110, 0
  v_mov_b32 v111, 0
  s_barrier
  v_add_u32 v132, s35, v126
  v_xor_b32 v133, 32, v132
  v_xor_b32 v134, 64, v132
  v_xor_b32 v135, 96, v132
  v_add_u32 v122, s35, v120
  v_add_u32 v123, s35, v121
  s_add_u32 s35, s35, 40960
  s_cmp_eq_u32 s35, 163840
  s_cselect_b32 s35, 0, s35
  ds_read_b128 v[148:151], v122 offset:0
  ds_read_b128 v[152:155], v122 offset:2048
  ds_read_b64_tr_b16 v[164:165], v132 offset:0
  ds_read_b64_tr_b16 v[166:167], v132 offset:3072
  ds_read_b64_tr_b16 v[168:169], v133 offset:0
  ds_read_b64_tr_b16 v[170:171], v133 offset:3072
  ds_read_b64_tr_b16 v[172:173], v134 offset:0
  ds_read_b64_tr_b16 v[174:175], v134 offset:3072
  ds_read_b64_tr_b16 v[176:177], v135 offset:0
  ds_read_b64_tr_b16 v[178:179], v135 offset:3072
  ds_read_b64_tr_b16 v[180:181], v132 offset:1024
  ds_read_b64_tr_b16 v[182:183], v132 offset:4096
  ds_read_b64_tr_b16 v[184:185], v133 offset:1024
  ds_read_b64_tr_b16 v[186:187], v133 offset:4096
  s_mov_b32 s34, 4
L_gemm1_kernel_loop0:
  ds_read_b64_tr_b16 v[188:189], v134 offset:1024
  ds_read_b64_tr_b16 v[190:191], v134 offset:4096
  s_waitcnt lgkmcnt(12)
  v_mfma_f32_16x16x32_bf16 v[0:3], v[164:167], v[148:151], v[0:3]
  v_mfma_f32_16x16x32_bf16 v[48:51], v[164:167], v[152:155], v[48:51]
  ds_read_b64_tr_b16 v[192:193], v135 offset:1024
  ds_read_b64_tr_b16 v[194:195], v135 offset:4096
  s_waitcnt lgkmcnt(12)
  v_mfma_f32_16x16x32_bf16 v[4:7], v[168:171], v[148:151], v[4:7]
  v_mfma_f32_16x16x32_bf16 v[96:99], v[112:115], v[148:151], v[96:99]
  v_mfma_f32_16x16x32_bf16 v[52:55], v[168:171], v[152:155], v[52:55]
  v_mfma_f32_16x16x32_bf16 v[104:107], v[112:115], v[152:155], v[104:107]
  ds_read_b64_tr_b16 v[164:165], v132 offset:2048
  ds_read_b64_tr_b16 v[166:167], v132 offset:5120
  s_waitcnt lgkmcnt(12)
  v_mfma_f32_16x16x32_bf16 v[8:11], v[172:175], v[148:151], v[8:11]
  v_mfma_f32_16x16x32_bf16 v[100:103], v[148:151], v[148:151], v[100:103]
  v_mfma_f32_16x16x32_bf16 v[56:59], v[172:175], v[152:155], v[56:59]
  v_mfma_f32_16x16x32_bf16 v[108:111], v[152:155], v[152:155], v[108:111]
  ds_read_b64_tr_b16 v[168:169], v133 offset:2048
  ds_read_b64_tr_b16 v[170:171], v133 offset:5120
  s_waitcnt lgkmcnt(12)
  v_mfma_f32_16x16x32_bf16 v[12:15], v[176:179], v[148:151], v[12:15]
  v_mfma_f32_16x16x32_bf16 v[60:63], v[176:179], v[152:155], v[60:63]
  s_cmp_eq_u32 s34, 4
  s_cbranch_scc1 L_gemm1_sk0
  s_waitcnt vmcnt(3)
  v_mfma_f32_16x16x32_bf16 v[228:231], v[212:215], v[244:247], v[228:231]
L_gemm1_sk0:
  buffer_load_dwordx4 v[212:215], v248, s[4:7], s3 offen offset:0
  ds_read_b64_tr_b16 v[172:173], v134 offset:2048
  ds_read_b64_tr_b16 v[174:175], v134 offset:5120
  s_waitcnt lgkmcnt(12)
  v_mfma_f32_16x16x32_bf16 v[16:19], v[148:151], v[180:183], v[16:19]
  v_mfma_f32_16x16x32_bf16 v[64:67], v[152:155], v[180:183], v[64:67]
  ds_read_b64_tr_b16 v[176:177], v135 offset:2048
  ds_read_b64_tr_b16 v[178:179], v135 offset:5120
  s_waitcnt lgkmcnt(12)
  v_mfma_f32_16x16x32_bf16 v[20:23], v[148:151], v[184:187], v[20:23]
  v_mfma_f32_16x16x32_bf16 v[68:71], v[152:155], v[184:187], v[68:71]
  ds_read_b128 v[156:159], v123 offset:0
  ds_read_b128 v[160:163], v123 offset:2048
  ds_read_b64_tr_b16 v[180:181], v132 offset:12288
  ds_read_b64_tr_b16 v[182:183], v132 offset:15360
  s_waitcnt lgkmcnt(14)
  v_mfma_f32_16x16x32_bf16 v[24:27], v[148:151], v[188:191], v[24:27]
  v_mfma_f32_16x16x32_bf16 v[72:75], v[152:155], v[188:191], v[72:75]
  ds_read_b64_tr_b16 v[184:185], v133 offset:12288
  ds_read_b64_tr_b16 v[186:187], v133 offset:15360
  s_waitcnt lgkmcnt(14)
  v_mfma_f32_16x16x32_bf16 v[28:31], v[148:151], v[192:195], v[28:31]
  v_mfma_f32_16x16x32_bf16 v[76:79], v[152:155], v[192:195], v[76:79]
  ds_read_b64_tr_b16 v[188:189], v134 offset:12288
  ds_read_b64_tr_b16 v[190:191], v134 offset:15360
  s_waitcnt lgkmcnt(14)
  v_mfma_f32_16x16x32_bf16 v[32:35], v[148:151], v[164:167], v[32:35]
  v_mfma_f32_16x16x32_bf16 v[80:83], v[152:155], v[164:167], v[80:83]
  ds_read_b64_tr_b16 v[192:193], v135 offset:12288
  ds_read_b64_tr_b16 v[194:195], v135 offset:15360
  s_waitcnt lgkmcnt(14)
  v_mfma_f32_16x16x32_bf16 v[36:39], v[148:151], v[168:171], v[36:39]
  v_mfma_f32_16x16x32_bf16 v[84:87], v[152:155], v[168:171], v[84:87]
  ds_read_b64_tr_b16 v[164:165], v132 offset:13312
  ds_read_b64_tr_b16 v[166:167], v132 offset:16384
  s_waitcnt lgkmcnt(14)
  v_mfma_f32_16x16x32_bf16 v[40:43], v[148:151], v[172:175], v[40:43]
  v_mfma_f32_16x16x32_bf16 v[88:91], v[152:155], v[172:175], v[88:91]
  ds_read_b64_tr_b16 v[168:169], v133 offset:13312
  ds_read_b64_tr_b16 v[170:171], v133 offset:16384
  s_waitcnt lgkmcnt(14)
  v_mfma_f32_16x16x32_bf16 v[44:47], v[148:151], v[176:179], v[44:47]
  v_mfma_f32_16x16x32_bf16 v[92:95], v[152:155], v[176:179], v[92:95]
  ds_read_b64_tr_b16 v[172:173], v134 offset:13312
  ds_read_b64_tr_b16 v[174:175], v134 offset:16384
  s_waitcnt lgkmcnt(12)
  v_mfma_f32_16x16x32_bf16 v[0:3], v[180:183], v[156:159], v[0:3]
  v_mfma_f32_16x16x32_bf16 v[48:51], v[180:183], v[160:163], v[48:51]
  ds_read_b64_tr_b16 v[176:177], v135 offset:13312
  ds_read_b64_tr_b16 v[178:179], v135 offset:16384
  s_waitcnt lgkmcnt(12)
  v_mfma_f32_16x16x32_bf16 v[4:7], v[184:187], v[156:159], v[4:7]
  v_mfma_f32_16x16x32_bf16 v[96:99], v[112:115], v[156:159], v[96:99]
  v_mfma_f32_16x16x32_bf16 v[52:55], v[184:187], v[160:163], v[52:55]
  v_mfma_f32_16x16x32_bf16 v[104:107], v[112:115], v[160:163], v[104:107]
  ds_read_b64_tr_b16 v[180:181], v132 offset:14336
  ds_read_b64_tr_b16 v[182:183], v132 offset:17408
  s_waitcnt lgkmcnt(12)
  v_mfma_f32_16x16x32_bf16 v[8:11], v[188:191], v[156:159], v[8:11]
  v_mfma_f32_16x16x32_bf16 v[100:103], v[156:159], v[156:159], v[100:103]
  v_mfma_f32_16x16x32_bf16 v[56:59], v[188:191], v[160:163], v[56:59]
  v_mfma_f32_16x16x32_bf16 v[108:111], v[160:163], v[160:163], v[108:111]
  ds_read_b64_tr_b16 v[184:185], v133 offset:14336
  ds_read_b64_tr_b16 v[186:187], v133 offset:17408
  s_waitcnt lgkmcnt(12)
  v_mfma_f32_16x16x32_bf16 v[12:15], v[192:195], v[156:159], v[12:15]
  v_mfma_f32_16x16x32_bf16 v[60:63], v[192:195], v[160:163], v[60:63]
  ds_read_b64_tr_b16 v[188:189], v134 offset:14336
  ds_read_b64_tr_b16 v[190:191], v134 offset:17408
  s_waitcnt lgkmcnt(12)
  v_mfma_f32_16x16x32_bf16 v[16:19], v[156:159], v[164:167], v[16:19]
  v_mfma_f32_16x16x32_bf16 v[64:67], v[160:163], v[164:167], v[64:67]
  ds_read_b64_tr_b16 v[192:193], v135 offset:14336
  ds_read_b64_tr_b16 v[194:195], v135 offset:17408
  s_waitcnt lgkmcnt(12)
  v_mfma_f32_16x16x32_bf16 v[20:23], v[156:159], v[168:171], v[20:23]
  v_mfma_f32_16x16x32_bf16 v[68:71], v[160:163], v[168:171], v[68:71]
  s_barrier
  v_add_u32 v136, s35, v126
  v_xor_b32 v137, 32, v136
  v_xor_b32 v138, 64, v136
  v_xor_b32 v139, 96, v136
  v_add_u32 v122, s35, v120
  v_add_u32 v123, s35, v121
  s_add_u32 s35, s35, 40960
  s_cmp_eq_u32 s35, 163840
  s_cselect_b32 s35, 0, s35
  ds_read_b128 v[148:151], v122 offset:0
  ds_read_b128 v[152:155], v122 offset:2048
  ds_read_b64_tr_b16 v[164:165], v136 offset:0
  ds_read_b64_tr_b16 v[166:167], v136 offset:3072
  s_waitcnt lgkmcnt(14)
  v_mfma_f32_16x16x32_bf16 v[24:27], v[156:159], v[172:175], v[24:27]
  v_mfma_f32_16x16x32_bf16 v[72:75], v[160:163], v[172:175], v[72:75]
  ds_read_b64_tr_b16 v[168:169], v137 offset:0
  ds_read_b64_tr_b16 v[170:171], v137 offset:3072
  s_waitcnt lgkmcnt(14)
  v_mfma_f32_16x16x32_bf16 v[28:31], v[156:159], v[176:179], v[28:31]
  v_mfma_f32_16x16x32_bf16 v[76:79], v[160:163], v[176:179], v[76:79]
  ds_read_b64_tr_b16 v[172:173], v138 offset:0
  ds_read_b64_tr_b16 v[174:175], v138 offset:3072
  s_waitcnt lgkmcnt(14)
  v_mfma_f32_16x16x32_bf16 v[32:35], v[156:159], v[180:183], v[32:35]
  v_mfma_f32_16x16x32_bf16 v[80:83], v[160:163], v[180:183], v[80:83]
  ds_read_b64_tr_b16 v[176:177], v139 offset:0
  ds_read_b64_tr_b16 v[178:179], v139 offset:3072
  s_waitcnt lgkmcnt(14)
  v_mfma_f32_16x16x32_bf16 v[36:39], v[156:159], v[184:187], v[36:39]
  v_mfma_f32_16x16x32_bf16 v[84:87], v[160:163], v[184:187], v[84:87]
  ds_read_b64_tr_b16 v[180:181], v136 offset:1024
  ds_read_b64_tr_b16 v[182:183], v136 offset:4096
  s_waitcnt lgkmcnt(14)
  v_mfma_f32_16x16x32_bf16 v[40:43], v[156:159], v[188:191], v[40:43]
  v_mfma_f32_16x16x32_bf16 v[88:91], v[160:163], v[188:191], v[88:91]
  ds_read_b64_tr_b16 v[184:185], v137 offset:1024
  ds_read_b64_tr_b16 v[186:187], v137 offset:4096
  s_waitcnt lgkmcnt(14)
  v_mfma_f32_16x16x32_bf16 v[44:47], v[156:159], v[192:195], v[44:47]
  v_mfma_f32_16x16x32_bf16 v[92:95], v[160:163], v[192:195], v[92:95]
  ds_read_b64_tr_b16 v[188:189], v138 offset:1024
  ds_read_b64_tr_b16 v[190:191], v138 offset:4096
  s_waitcnt lgkmcnt(12)
  v_mfma_f32_16x16x32_bf16 v[0:3], v[164:167], v[148:151], v[0:3]
  v_mfma_f32_16x16x32_bf16 v[48:51], v[164:167], v[152:155], v[48:51]
  ds_read_b64_tr_b16 v[192:193], v139 offset:1024
  ds_read_b64_tr_b16 v[194:195], v139 offset:4096
  s_waitcnt lgkmcnt(12)
  v_mfma_f32_16x16x32_bf16 v[4:7], v[168:171], v[148:151], v[4:7]
  v_mfma_f32_16x16x32_bf16 v[96:99], v[112:115], v[148:151], v[96:99]
  v_mfma_f32_16x16x32_bf16 v[52:55], v[168:171], v[152:155], v[52:55]
  v_mfma_f32_16x16x32_bf16 v[104:107], v[112:115], v[152:155], v[104:107]
  ds_read_b64_tr_b16 v[164:165], v136 offset:2048
  ds_read_b64_tr_b16 v[166:167], v136 offset:5120
  s_waitcnt lgkmcnt(12)
  v_mfma_f32_16x16x32_bf16 v[8:11], v[172:175], v[148:151], v[8:11]
  v_mfma_f32_16x16x32_bf16 v[100:103], v[148:151], v[148:151], v[100:103]
  v_mfma_f32_16x16x32_bf16 v[56:59], v[172:175], v[152:155], v[56:59]
  v_mfma_f32_16x16x32_bf16 v[108:111], v[152:155], v[152:155], v[108:111]
  ds_read_b64_tr_b16 v[168:169], v137 offset:2048
  ds_read_b64_tr_b16 v[170:171], v137 offset:5120
  s_waitcnt lgkmcnt(12)
  v_mfma_f32_16x16x32_bf16 v[12:15], v[176:179], v[148:151], v[12:15]
  v_mfma_f32_16x16x32_bf16 v[60:63], v[176:179], v[152:155], v[60:63]
  s_cmp_eq_u32 s34, 4
  s_cbranch_scc1 L_gemm1_sk1
  s_waitcnt vmcnt(3)
  v_mfma_f32_16x16x32_bf16 v[232:235], v[216:219], v[244:247], v[232:235]
L_gemm1_sk1:
  buffer_load_dwordx4 v[216:219], v248, s[4:7], s3 offen offset:256
  ds_read_b64_tr_b16 v[172:173], v138 offset:2048
  ds_read_b64_tr_b16 v[174:175], v138 offset:5120
  s_waitcnt lgkmcnt(12)
  v_mfma_f32_16x16x32_bf16 v[16:19], v[148:151], v[180:183], v[16:19]
  v_mfma_f32_16x16x32_bf16 v[64:67], v[152:155], v[180:183], v[64:67]
  s_cmp_lg_u32 s34, 1
  s_cbranch_scc1 L_gemm1_kernel_hk0
  buffer_store_dwordx4 v[252:255], v125, s[48:51], s53 offen sc0 sc1
L_gemm1_kernel_hk0:
  ds_read_b64_tr_b16 v[176:177], v139 offset:2048
  ds_read_b64_tr_b16 v[178:179], v139 offset:5120
  s_waitcnt lgkmcnt(12)
  v_mfma_f32_16x16x32_bf16 v[20:23], v[148:151], v[184:187], v[20:23]
  v_mfma_f32_16x16x32_bf16 v[68:71], v[152:155], v[184:187], v[68:71]
  s_cmp_lg_u32 s34, 3
  s_cbranch_scc1 L_gemm1_kernel_hk1
  buffer_load_dwordx4 v[252:255], v249, s[44:47], s52 offen
L_gemm1_kernel_hk1:
  ds_read_b128 v[156:159], v123 offset:0
  ds_read_b128 v[160:163], v123 offset:2048
  ds_read_b64_tr_b16 v[180:181], v136 offset:12288
  ds_read_b64_tr_b16 v[182:183], v136 offset:15360
  s_waitcnt lgkmcnt(14)
  v_mfma_f32_16x16x32_bf16 v[24:27], v[148:151], v[188:191], v[24:27]
  v_mfma_f32_16x16x32_bf16 v[72:75], v[152:155], v[188:191], v[72:75]
  ds_read_b64_tr_b16 v[184:185], v137 offset:12288
  ds_read_b64_tr_b16 v[186:187], v137 offset:15360
  s_waitcnt lgkmcnt(14)
  v_mfma_f32_16x16x32_bf16 v[28:31], v[148:151], v[192:195], v[28:31]
  v_mfma_f32_16x16x32_bf16 v[76:79], v[152:155], v[192:195], v[76:79]
  ds_read_b64_tr_b16 v[188:189], v138 offset:12288
  ds_read_b64_tr_b16 v[190:191], v138 offset:15360
  s_waitcnt lgkmcnt(14)
  v_mfma_f32_16x16x32_bf16 v[32:35], v[148:151], v[164:167], v[32:35]
  v_mfma_f32_16x16x32_bf16 v[80:83], v[152:155], v[164:167], v[80:83]
  ds_read_b64_tr_b16 v[192:193], v139 offset:12288
  ds_read_b64_tr_b16 v[194:195], v139 offset:15360
  s_waitcnt lgkmcnt(14)
  v_mfma_f32_16x16x32_bf16 v[36:39], v[148:151], v[168:171], v[36:39]
  v_mfma_f32_16x16x32_bf16 v[84:87], v[152:155], v[168:171], v[84:87]
  ds_read_b64_tr_b16 v[164:165], v136 offset:13312
  ds_read_b64_tr_b16 v[166:167], v136 offset:16384
  s_waitcnt lgkmcnt(14)
  v_mfma_f32_16x16x32_bf16 v[40:43], v[148:151], v[172:175], v[40:43]
  v_mfma_f32_16x16x32_bf16 v[88:91], v[152:155], v[172:175], v[88:91]
  ds_read_b64_tr_b16 v[168:169], v137 offset:13312
  ds_read_b64_tr_b16 v[170:171], v137 offset:16384
  s_waitcnt lgkmcnt(14)
  v_mfma_f32_16x16x32_bf16 v[44:47], v[148:151], v[176:179], v[44:47]
  v_mfma_f32_16x16x32_bf16 v[92:95], v[152:155], v[176:179], v[92:95]
  ds_read_b64_tr_b16 v[172:173], v138 offset:13312
  ds_read_b64_tr_b16 v[174:175], v138 offset:16384
  s_waitcnt lgkmcnt(12)
  v_mfma_f32_16x16x32_bf16 v[0:3], v[180:183], v[156:159], v[0:3]
  v_mfma_f32_16x16x32_bf16 v[48:51], v[180:183], v[160:163], v[48:51]
  ds_read_b64_tr_b16 v[176:177], v139 offset:13312
  ds_read_b64_tr_b16 v[178:179], v139 offset:16384
  s_waitcnt lgkmcnt(12)
  v_mfma_f32_16x16x32_bf16 v[4:7], v[184:187], v[156:159], v[4:7]
  v_mfma_f32_16x16x32_bf16 v[96:99], v[112:115], v[156:159], v[96:99]
  v_mfma_f32_16x16x32_bf16 v[52:55], v[184:187], v[160:163], v[52:55]
  v_mfma_f32_16x16x32_bf16 v[104:107], v[112:115], v[160:163], v[104:107]
  ds_read_b64_tr_b16 v[180:181], v136 offset:14336
  ds_read_b64_tr_b16 v[182:183], v136 offset:17408
  s_waitcnt lgkmcnt(12)
  v_mfma_f32_16x16x32_bf16 v[8:11], v[188:191], v[156:159], v[8:11]
  v_mfma_f32_16x16x32_bf16 v[100:103], v[156:159], v[156:159], v[100:103]
  v_mfma_f32_16x16x32_bf16 v[56:59], v[188:191], v[160:163], v[56:59]
  v_mfma_f32_16x16x32_bf16 v[108:111], v[160:163], v[160:163], v[108:111]
  ds_read_b64_tr_b16 v[184:185], v137 offset:14336
  ds_read_b64_tr_b16 v[186:187], v137 offset:17408
  s_waitcnt lgkmcnt(12)
  v_mfma_f32_16x16x32_bf16 v[12:15], v[192:195], v[156:159], v[12:15]
  v_mfma_f32_16x16x32_bf16 v[60:63], v[192:195], v[160:163], v[60:63]
  ds_read_b64_tr_b16 v[188:189], v138 offset:14336
  ds_read_b64_tr_b16 v[190:191], v138 offset:17408
  s_waitcnt lgkmcnt(12)
  v_mfma_f32_16x16x32_bf16 v[16:19], v[156:159], v[164:167], v[16:19]
  v_mfma_f32_16x16x32_bf16 v[64:67], v[160:163], v[164:167], v[64:67]
  ds_read_b64_tr_b16 v[192:193], v139 offset:14336
  ds_read_b64_tr_b16 v[194:195], v139 offset:17408
  s_waitcnt lgkmcnt(12)
  v_mfma_f32_16x16x32_bf16 v[20:23], v[156:159], v[168:171], v[20:23]
  v_mfma_f32_16x16x32_bf16 v[68:71], v[160:163], v[168:171], v[68:71]
  s_barrier
  v_add_u32 v132, s35, v126
  v_xor_b32 v133, 32, v132
  v_xor_b32 v134, 64, v132
  v_xor_b32 v135, 96, v132
  v_add_u32 v122, s35, v120
  v_add_u32 v123, s35, v121
  s_add_u32 s35, s35, 40960
  s_cmp_eq_u32 s35, 163840
  s_cselect_b32 s35, 0, s35
  ds_read_b128 v[148:151], v122 offset:0
  ds_read_b128 v[152:155], v122 offset:2048
  ds_read_b64_tr_b16 v[164:165], v132 offset:0
  ds_read_b64_tr_b16 v[166:167], v132 offset:3072
  s_waitcnt lgkmcnt(14)
  v_mfma_f32_16x16x32_bf16 v[24:27], v[156:159], v[172:175], v[24:27]
  v_mfma_f32_16x16x32_bf16 v[72:75], v[160:163], v[172:175], v[72:75]
  ds_read_b64_tr_b16 v[168:169], v133 offset:0
  ds_read_b64_tr_b16 v[170:171], v133 offset:3072
  s_waitcnt lgkmcnt(14)
  v_mfma_f32_16x16x32_bf16 v[28:31], v[156:159], v[176:179], v[28:31]
  v_mfma_f32_16x16x32_bf16 v[76:79], v[160:163], v[176:179], v[76:79]
  ds_read_b64_tr_b16 v[172:173], v134 offset:0
  ds_read_b64_tr_b16 v[174:175], v134 offset:3072
  s_waitcnt lgkmcnt(14)
  v_mfma_f32_16x16x32_bf16 v[32:35], v[156:159], v[180:183], v[32:35]
  v_mfma_f32_16x16x32_bf16 v[80:83], v[160:163], v[180:183], v[80:83]
  ds_read_b64_tr_b16 v[176:177], v135 offset:0
  ds_read_b64_tr_b16 v[178:179], v135 offset:3072
  s_waitcnt lgkmcnt(14)
  v_mfma_f32_16x16x32_bf16 v[36:39], v[156:159], v[184:187], v[36:39]
  v_mfma_f32_16x16x32_bf16 v[84:87], v[160:163], v[184:187], v[84:87]
  ds_read_b64_tr_b16 v[180:181], v132 offset:1024
  ds_read_b64_tr_b16 v[182:183], v132 offset:4096
  s_waitcnt lgkmcnt(14)
  v_mfma_f32_16x16x32_bf16 v[40:43], v[156:159], v[188:191], v[40:43]
  v_mfma_f32_16x16x32_bf16 v[88:91], v[160:163], v[188:191], v[88:91]
  ds_read_b64_tr_b16 v[184:185], v133 offset:1024
  ds_read_b64_tr_b16 v[186:187], v133 offset:4096
  s_waitcnt lgkmcnt(14)
  v_mfma_f32_16x16x32_bf16 v[44:47], v[156:159], v[192:195], v[44:47]
  v_mfma_f32_16x16x32_bf16 v[92:95], v[160:163], v[192:195], v[92:95]
  ds_read_b64_tr_b16 v[188:189], v134 offset:1024
  ds_read_b64_tr_b16 v[190:191], v134 offset:4096
  s_waitcnt lgkmcnt(12)
  v_mfma_f32_16x16x32_bf16 v[0:3], v[164:167], v[148:151], v[0:3]
  v_mfma_f32_16x16x32_bf16 v[48:51], v[164:167], v[152:155], v[48:51]
  ds_read_b64_tr_b16 v[192:193], v135 offset:1024
  ds_read_b64_tr_b16 v[194:195], v135 offset:4096
  s_waitcnt lgkmcnt(12)
  v_mfma_f32_16x16x32_bf16 v[4:7], v[168:171], v[148:151], v[4:7]
  v_mfma_f32_16x16x32_bf16 v[96:99], v[112:115], v[148:151], v[96:99]
  v_mfma_f32_16x16x32_bf16 v[52:55], v[168:171], v[152:155], v[52:55]
  v_mfma_f32_16x16x32_bf16 v[104:107], v[112:115], v[152:155], v[104:107]
  ds_read_b64_tr_b16 v[164:165], v132 offset:2048
  ds_read_b64_tr_b16 v[166:167], v132 offset:5120
  s_waitcnt lgkmcnt(12)
  v_mfma_f32_16x16x32_bf16 v[8:11], v[172:175], v[148:151], v[8:11]
  v_mfma_f32_16x16x32_bf16 v[100:103], v[148:151], v[148:151], v[100:103]
  v_mfma_f32_16x16x32_bf16 v[56:59], v[172:175], v[152:155], v[56:59]
  v_mfma_f32_16x16x32_bf16 v[108:111], v[152:155], v[152:155], v[108:111]
  ds_read_b64_tr_b16 v[168:169], v133 offset:2048
  ds_read_b64_tr_b16 v[170:171], v133 offset:5120
  s_waitcnt lgkmcnt(12)
  v_mfma_f32_16x16x32_bf16 v[12:15], v[176:179], v[148:151], v[12:15]
  v_mfma_f32_16x16x32_bf16 v[60:63], v[176:179], v[152:155], v[60:63]
  s_cmp_eq_u32 s34, 4
  s_cbranch_scc1 L_gemm1_sk2
  s_waitcnt vmcnt(3)
  v_mfma_f32_16x16x32_bf16 v[236:239], v[220:223], v[244:247], v[236:239]
L_gemm1_sk2:
  buffer_load_dwordx4 v[220:223], v248, s[4:7], s3 offen offset:512
  ds_read_b64_tr_b16 v[172:173], v134 offset:2048
  ds_read_b64_tr_b16 v[174:175], v134 offset:5120
  s_waitcnt lgkmcnt(12)
  v_mfma_f32_16x16x32_bf16 v[16:19], v[148:151], v[180:183], v[16:19]
  v_mfma_f32_16x16x32_bf16 v[64:67], v[152:155], v[180:183], v[64:67]
  ds_read_b64_tr_b16 v[176:177], v135 offset:2048
  ds_read_b64_tr_b16 v[178:179], v135 offset:5120
  s_waitcnt lgkmcnt(12)
  v_mfma_f32_16x16x32_bf16 v[20:23], v[148:151], v[184:187], v[20:23]
  v_mfma_f32_16x16x32_bf16 v[68:71], v[152:155], v[184:187], v[68:71]
  ds_read_b128 v[156:159], v123 offset:0
  ds_read_b128 v[160:163], v123 offset:2048
  ds_read_b64_tr_b16 v[180:181], v132 offset:12288
  ds_read_b64_tr_b16 v[182:183], v132 offset:15360
  s_waitcnt lgkmcnt(14)
  v_mfma_f32_16x16x32_bf16 v[24:27], v[148:151], v[188:191], v[24:27]
  v_mfma_f32_16x16x32_bf16 v[72:75], v[152:155], v[188:191], v[72:75]
  ds_read_b64_tr_b16 v[184:185], v133 offset:12288
  ds_read_b64_tr_b16 v[186:187], v133 offset:15360
  s_waitcnt lgkmcnt(14)
  v_mfma_f32_16x16x32_bf16 v[28:31], v[148:151], v[192:195], v[28:31]
  v_mfma_f32_16x16x32_bf16 v[76:79], v[152:155], v[192:195], v[76:79]
  ds_read_b64_tr_b16 v[188:189], v134 offset:12288
  ds_read_b64_tr_b16 v[190:191], v134 offset:15360
  s_waitcnt lgkmcnt(14)
  v_mfma_f32_16x16x32_bf16 v[32:35], v[148:151], v[164:167], v[32:35]
  v_mfma_f32_16x16x32_bf16 v[80:83], v[152:155], v[164:167], v[80:83]
  ds_read_b64_tr_b16 v[192:193], v135 offset:12288
  ds_read_b64_tr_b16 v[194:195], v135 offset:15360
  s_waitcnt lgkmcnt(14)
  v_mfma_f32_16x16x32_bf16 v[36:39], v[148:151], v[168:171], v[36:39]
  v_mfma_f32_16x16x32_bf16 v[84:87], v[152:155], v[168:171], v[84:87]
  ds_read_b64_tr_b16 v[164:165], v132 offset:13312
  ds_read_b64_tr_b16 v[166:167], v132 offset:16384
  s_waitcnt lgkmcnt(14)
  v_mfma_f32_16x16x32_bf16 v[40:43], v[148:151], v[172:175], v[40:43]
  v_mfma_f32_16x16x32_bf16 v[88:91], v[152:155], v[172:175], v[88:91]
  ds_read_b64_tr_b16 v[168:169], v133 offset:13312
  ds_read_b64_tr_b16 v[170:171], v133 offset:16384
  s_waitcnt lgkmcnt(14)
  v_mfma_f32_16x16x32_bf16 v[44:47], v[148:151], v[176:179], v[44:47]
  v_mfma_f32_16x16x32_bf16 v[92:95], v[152:155], v[176:179], v[92:95]
  ds_read_b64_tr_b16 v[172:173], v134 offset:13312
  ds_read_b64_tr_b16 v[174:175], v134 offset:16384
  s_waitcnt lgkmcnt(12)
  v_mfma_f32_16x16x32_bf16 v[0:3], v[180:183], v[156:159], v[0:3]
  v_mfma_f32_16x16x32_bf16 v[48:51], v[180:183], v[160:163], v[48:51]
  ds_read_b64_tr_b16 v[176:177], v135 offset:13312
  ds_read_b64_tr_b16 v[178:179], v135 offset:16384
  s_waitcnt lgkmcnt(12)
  v_mfma_f32_16x16x32_bf16 v[4:7], v[184:187], v[156:159], v[4:7]
  v_mfma_f32_16x16x32_bf16 v[96:99], v[112:115], v[156:159], v[96:99]
  v_mfma_f32_16x16x32_bf16 v[52:55], v[184:187], v[160:163], v[52:55]
  v_mfma_f32_16x16x32_bf16 v[104:107], v[112:115], v[160:163], v[104:107]
  ds_read_b64_tr_b16 v[180:181], v132 offset:14336
  ds_read_b64_tr_b16 v[182:183], v132 offset:17408
  s_waitcnt lgkmcnt(12)
  v_mfma_f32_16x16x32_bf16 v[8:11], v[188:191], v[156:159], v[8:11]
  v_mfma_f32_16x16x32_bf16 v[100:103], v[156:159], v[156:159], v[100:103]
  v_mfma_f32_16x16x32_bf16 v[56:59], v[188:191], v[160:163], v[56:59]
  v_mfma_f32_16x16x32_bf16 v[108:111], v[160:163], v[160:163], v[108:111]
  ds_read_b64_tr_b16 v[184:185], v133 offset:14336
  ds_read_b64_tr_b16 v[186:187], v133 offset:17408
  s_waitcnt lgkmcnt(12)
  v_mfma_f32_16x16x32_bf16 v[12:15], v[192:195], v[156:159], v[12:15]
  v_mfma_f32_16x16x32_bf16 v[60:63], v[192:195], v[160:163], v[60:63]
  ds_read_b64_tr_b16 v[188:189], v134 offset:14336
  ds_read_b64_tr_b16 v[190:191], v134 offset:17408
  s_waitcnt lgkmcnt(12)
  v_mfma_f32_16x16x32_bf16 v[16:19], v[156:159], v[164:167], v[16:19]
  v_mfma_f32_16x16x32_bf16 v[64:67], v[160:163], v[164:167], v[64:67]
  ds_read_b64_tr_b16 v[192:193], v135 offset:14336
  ds_read_b64_tr_b16 v[194:195], v135 offset:17408
  s_waitcnt lgkmcnt(12)
  v_mfma_f32_16x16x32_bf16 v[20:23], v[156:159], v[168:171], v[20:23]
  v_mfma_f32_16x16x32_bf16 v[68:71], v[160:163], v[168:171], v[68:71]
  s_barrier
  v_add_u32 v136, s35, v126
  v_xor_b32 v137, 32, v136
  v_xor_b32 v138, 64, v136
  v_xor_b32 v139, 96, v136
  v_add_u32 v122, s35, v120
  v_add_u32 v123, s35, v121
  s_add_u32 s35, s35, 40960
  s_cmp_eq_u32 s35, 163840
  s_cselect_b32 s35, 0, s35
  ds_read_b128 v[148:151], v122 offset:0
  ds_read_b128 v[152:155], v122 offset:2048
  ds_read_b64_tr_b16 v[164:165], v136 offset:0
  ds_read_b64_tr_b16 v[166:167], v136 offset:3072
  s_waitcnt lgkmcnt(14)
  v_mfma_f32_16x16x32_bf16 v[24:27], v[156:159], v[172:175], v[24:27]
  v_mfma_f32_16x16x32_bf16 v[72:75], v[160:163], v[172:175], v[72:75]
  ds_read_b64_tr_b16 v[168:169], v137 offset:0
  ds_read_b64_tr_b16 v[170:171], v137 offset:3072
  s_waitcnt lgkmcnt(14)
  v_mfma_f32_16x16x32_bf16 v[28:31], v[156:159], v[176:179], v[28:31]
  v_mfma_f32_16x16x32_bf16 v[76:79], v[160:163], v[176:179], v[76:79]
  ds_read_b64_tr_b16 v[172:173], v138 offset:0
  ds_read_b64_tr_b16 v[174:175], v138 offset:3072
  s_waitcnt lgkmcnt(14)
  v_mfma_f32_16x16x32_bf16 v[32:35], v[156:159], v[180:183], v[32:35]
  v_mfma_f32_16x16x32_bf16 v[80:83], v[160:163], v[180:183], v[80:83]
  ds_read_b64_tr_b16 v[176:177], v139 offset:0
  ds_read_b64_tr_b16 v[178:179], v139 offset:3072
  s_waitcnt lgkmcnt(14)
  v_mfma_f32_16x16x32_bf16 v[36:39], v[156:159], v[184:187], v[36:39]
  v_mfma_f32_16x16x32_bf16 v[84:87], v[160:163], v[184:187], v[84:87]
  ds_read_b64_tr_b16 v[180:181], v136 offset:1024
  ds_read_b64_tr_b16 v[182:183], v136 offset:4096
  s_waitcnt lgkmcnt(14)
  v_mfma_f32_16x16x32_bf16 v[40:43], v[156:159], v[188:191], v[40:43]
  v_mfma_f32_16x16x32_bf16 v[88:91], v[160:163], v[188:191], v[88:91]
  ds_read_b64_tr_b16 v[184:185], v137 offset:1024
  ds_read_b64_tr_b16 v[186:187], v137 offset:4096
  s_waitcnt lgkmcnt(14)
  v_mfma_f32_16x16x32_bf16 v[44:47], v[156:159], v[192:195], v[44:47]
  v_mfma_f32_16x16x32_bf16 v[92:95], v[160:163], v[192:195], v[92:95]
  ds_read_b64_tr_b16 v[188:189], v138 offset:1024
  ds_read_b64_tr_b16 v[190:191], v138 offset:4096
  s_waitcnt lgkmcnt(12)
  v_mfma_f32_16x16x32_bf16 v[0:3], v[164:167], v[148:151], v[0:3]
  v_mfma_f32_16x16x32_bf16 v[48:51], v[164:167], v[152:155], v[48:51]
  ds_read_b64_tr_b16 v[192:193], v139 offset:1024
  ds_read_b64_tr_b16 v[194:195], v139 offset:4096
  s_waitcnt lgkmcnt(12)
  v_mfma_f32_16x16x32_bf16 v[4:7], v[168:171], v[148:151], v[4:7]
  v_mfma_f32_16x16x32_bf16 v[96:99], v[112:115], v[148:151], v[96:99]
  v_mfma_f32_16x16x32_bf16 v[52:55], v[168:171], v[152:155], v[52:55]
  v_mfma_f32_16x16x32_bf16 v[104:107], v[112:115], v[152:155], v[104:107]
  ds_read_b64_tr_b16 v[164:165], v136 offset:2048
  ds_read_b64_tr_b16 v[166:167], v136 offset:5120
  s_waitcnt lgkmcnt(12)
  v_mfma_f32_16x16x32_bf16 v[8:11], v[172:175], v[148:151], v[8:11]
  v_mfma_f32_16x16x32_bf16 v[100:103], v[148:151], v[148:151], v[100:103]
  v_mfma_f32_16x16x32_bf16 v[56:59], v[172:175], v[152:155], v[56:59]
  v_mfma_f32_16x16x32_bf16 v[108:111], v[152:155], v[152:155], v[108:111]
  ds_read_b64_tr_b16 v[168:169], v137 offset:2048
  ds_read_b64_tr_b16 v[170:171], v137 offset:5120
  s_waitcnt lgkmcnt(12)
  v_mfma_f32_16x16x32_bf16 v[12:15], v[176:179], v[148:151], v[12:15]
  v_mfma_f32_16x16x32_bf16 v[60:63], v[176:179], v[152:155], v[60:63]
  s_cmp_eq_u32 s34, 4
  s_cbranch_scc1 L_gemm1_sk3
  s_waitcnt vmcnt(3)
  v_mfma_f32_16x16x32_bf16 v[240:243], v[224:227], v[244:247], v[240:243]
L_gemm1_sk3:
  buffer_load_dwordx4 v[224:227], v248, s[4:7], s3 offen offset:768
  s_add_u32 s3, s3, 28672
  ds_read_b64_tr_b16 v[172:173], v138 offset:2048
  ds_read_b64_tr_b16 v[174:175], v138 offset:5120
  s_waitcnt lgkmcnt(12)
  v_mfma_f32_16x16x32_bf16 v[16:19], v[148:151], v[180:183], v[16:19]
  v_mfma_f32_16x16x32_bf16 v[64:67], v[152:155], v[180:183], v[64:67]
  ds_read_b64_tr_b16 v[176:177], v139 offset:2048
  ds_read_b64_tr_b16 v[178:179], v139 offset:5120
  s_waitcnt lgkmcnt(12)
  v_mfma_f32_16x16x32_bf16 v[20:23], v[148:151], v[184:187], v[20:23]
  v_mfma_f32_16x16x32_bf16 v[68:71], v[152:155], v[184:187], v[68:71]
  ds_read_b128 v[156:159], v123 offset:0
  ds_read_b128 v[160:163], v123 offset:2048
  ds_read_b64_tr_b16 v[180:181], v136 offset:12288
  ds_read_b64_tr_b16 v[182:183], v136 offset:15360
  s_waitcnt lgkmcnt(14)
  v_mfma_f32_16x16x32_bf16 v[24:27], v[148:151], v[188:191], v[24:27]
  v_mfma_f32_16x16x32_bf16 v[72:75], v[152:155], v[188:191], v[72:75]
  ds_read_b64_tr_b16 v[184:185], v137 offset:12288
  ds_read_b64_tr_b16 v[186:187], v137 offset:15360
  s_waitcnt lgkmcnt(14)
  v_mfma_f32_16x16x32_bf16 v[28:31], v[148:151], v[192:195], v[28:31]
  v_mfma_f32_16x16x32_bf16 v[76:79], v[152:155], v[192:195], v[76:79]
  ds_read_b64_tr_b16 v[188:189], v138 offset:12288
  ds_read_b64_tr_b16 v[190:191], v138 offset:15360
  s_waitcnt lgkmcnt(14)
  v_mfma_f32_16x16x32_bf16 v[32:35], v[148:151], v[164:167], v[32:35]
  v_mfma_f32_16x16x32_bf16 v[80:83], v[152:155], v[164:167], v[80:83]
  ds_read_b64_tr_b16 v[192:193], v139 offset:12288
  ds_read_b64_tr_b16 v[194:195], v139 offset:15360
  s_waitcnt lgkmcnt(14)
  v_mfma_f32_16x16x32_bf16 v[36:39], v[148:151], v[168:171], v[36:39]
  v_mfma_f32_16x16x32_bf16 v[84:87], v[152:155], v[168:171], v[84:87]
  ds_read_b64_tr_b16 v[164:165], v136 offset:13312
  ds_read_b64_tr_b16 v[166:167], v136 offset:16384
  s_waitcnt lgkmcnt(14)
  v_mfma_f32_16x16x32_bf16 v[40:43], v[148:151], v[172:175], v[40:43]
  v_mfma_f32_16x16x32_bf16 v[88:91], v[152:155], v[172:175], v[88:91]
  ds_read_b64_tr_b16 v[168:169], v137 offset:13312
  ds_read_b64_tr_b16 v[170:171], v137 offset:16384
  s_waitcnt lgkmcnt(14)
  v_mfma_f32_16x16x32_bf16 v[44:47], v[148:151], v[176:179], v[44:47]
  v_mfma_f32_16x16x32_bf16 v[92:95], v[152:155], v[176:179], v[92:95]
  ds_read_b64_tr_b16 v[172:173], v138 offset:13312
  ds_read_b64_tr_b16 v[174:175], v138 offset:16384
  s_waitcnt lgkmcnt(12)
  v_mfma_f32_16x16x32_bf16 v[0:3], v[180:183], v[156:159], v[0:3]
  v_mfma_f32_16x16x32_bf16 v[48:51], v[180:183], v[160:163], v[48:51]
  ds_read_b64_tr_b16 v[176:177], v139 offset:13312
  ds_read_b64_tr_b16 v[178:179], v139 offset:16384
  s_waitcnt lgkmcnt(12)
  v_mfma_f32_16x16x32_bf16 v[4:7], v[184:187], v[156:159], v[4:7]
  v_mfma_f32_16x16x32_bf16 v[96:99], v[112:115], v[156:159], v[96:99]
  v_mfma_f32_16x16x32_bf16 v[52:55], v[184:187], v[160:163], v[52:55]
  v_mfma_f32_16x16x32_bf16 v[104:107], v[112:115], v[160:163], v[104:107]
  ds_read_b64_tr_b16 v[180:181], v136 offset:14336
  ds_read_b64_tr_b16 v[182:183], v136 offset:17408
  s_waitcnt lgkmcnt(12)
  v_mfma_f32_16x16x32_bf16 v[8:11], v[188:191], v[156:159], v[8:11]
  v_mfma_f32_16x16x32_bf16 v[100:103], v[156:159], v[156:159], v[100:103]
  v_mfma_f32_16x16x32_bf16 v[56:59], v[188:191], v[160:163], v[56:59]
  v_mfma_f32_16x16x32_bf16 v[108:111], v[160:163], v[160:163], v[108:111]
  ds_read_b64_tr_b16 v[184:185], v137 offset:14336
  ds_read_b64_tr_b16 v[186:187], v137 offset:17408
  s_waitcnt lgkmcnt(12)
  v_mfma_f32_16x16x32_bf16 v[12:15], v[192:195], v[156:159], v[12:15]
  v_mfma_f32_16x16x32_bf16 v[60:63], v[192:195], v[160:163], v[60:63]
  ds_read_b64_tr_b16 v[188:189], v138 offset:14336
  ds_read_b64_tr_b16 v[190:191], v138 offset:17408
  s_waitcnt lgkmcnt(12)
  v_mfma_f32_16x16x32_bf16 v[16:19], v[156:159], v[164:167], v[16:19]
  v_mfma_f32_16x16x32_bf16 v[64:67], v[160:163], v[164:167], v[64:67]
  ds_read_b64_tr_b16 v[192:193], v139 offset:14336
  ds_read_b64_tr_b16 v[194:195], v139 offset:17408
  s_waitcnt lgkmcnt(12)
  v_mfma_f32_16x16x32_bf16 v[20:23], v[156:159], v[168:171], v[20:23]
  v_mfma_f32_16x16x32_bf16 v[68:71], v[160:163], v[168:171], v[68:71]
  s_barrier
  v_add_u32 v132, s35, v126
  v_xor_b32 v133, 32, v132
  v_xor_b32 v134, 64, v132
  v_xor_b32 v135, 96, v132
  v_add_u32 v122, s35, v120
  v_add_u32 v123, s35, v121
  s_add_u32 s35, s35, 40960
  s_cmp_eq_u32 s35, 163840
  s_cselect_b32 s35, 0, s35
  ds_read_b128 v[148:151], v122 offset:0
  ds_read_b128 v[152:155], v122 offset:2048
  ds_read_b64_tr_b16 v[164:165], v132 offset:0
  ds_read_b64_tr_b16 v[166:167], v132 offset:3072
  s_waitcnt lgkmcnt(14)
  v_mfma_f32_16x16x32_bf16 v[24:27], v[156:159], v[172:175], v[24:27]
  v_mfma_f32_16x16x32_bf16 v[72:75], v[160:163], v[172:175], v[72:75]
  ds_read_b64_tr_b16 v[168:169], v133 offset:0
  ds_read_b64_tr_b16 v[170:171], v133 offset:3072
  s_waitcnt lgkmcnt(14)
  v_mfma_f32_16x16x32_bf16 v[28:31], v[156:159], v[176:179], v[28:31]
  v_mfma_f32_16x16x32_bf16 v[76:79], v[160:163], v[176:179], v[76:79]
  ds_read_b64_tr_b16 v[172:173], v134 offset:0
  ds_read_b64_tr_b16 v[174:175], v134 offset:3072
  s_waitcnt lgkmcnt(14)
  v_mfma_f32_16x16x32_bf16 v[32:35], v[156:159], v[180:183], v[32:35]
  v_mfma_f32_16x16x32_bf16 v[80:83], v[160:163], v[180:183], v[80:83]
  ds_read_b64_tr_b16 v[176:177], v135 offset:0
  ds_read_b64_tr_b16 v[178:179], v135 offset:3072
  s_waitcnt lgkmcnt(14)
  v_mfma_f32_16x16x32_bf16 v[36:39], v[156:159], v[184:187], v[36:39]
  v_mfma_f32_16x16x32_bf16 v[84:87], v[160:163], v[184:187], v[84:87]
  ds_read_b64_tr_b16 v[180:181], v132 offset:1024
  ds_read_b64_tr_b16 v[182:183], v132 offset:4096
  s_waitcnt lgkmcnt(14)
  v_mfma_f32_16x16x32_bf16 v[40:43], v[156:159], v[188:191], v[40:43]
  v_mfma_f32_16x16x32_bf16 v[88:91], v[160:163], v[188:191], v[88:91]
  ds_read_b64_tr_b16 v[184:185], v133 offset:1024
  ds_read_b64_tr_b16 v[186:187], v133 offset:4096
  s_waitcnt lgkmcnt(14)
  v_mfma_f32_16x16x32_bf16 v[44:47], v[156:159], v[192:195], v[44:47]
  v_mfma_f32_16x16x32_bf16 v[92:95], v[160:163], v[192:195], v[92:95]
  s_sub_u32 s34, s34, 1
  s_cmp_lg_u32 s34, 0
  s_cbranch_scc1 L_gemm1_kernel_loop0
L_gemm1_kernel_join:
  s_waitcnt lgkmcnt(0)
  s_nop 7
  s_nop 7
  s_add_u32 s8, s82, 4194304
  s_addc_u32 s9, s83, 0
  s_mov_b32 s10, 4194304
  s_mov_b32 s11, 0x20000
  s_add_u32 s12, s82, 8388608
  s_addc_u32 s13, s83, 0
  s_mov_b32 s14, 3145728
  s_mov_b32 s15, 0x20000
  s_waitcnt vmcnt(0)
  v_mfma_f32_16x16x32_bf16 v[228:231], v[212:215], v[244:247], v[228:231]
  v_mfma_f32_16x16x32_bf16 v[232:235], v[216:219], v[244:247], v[232:235]
  v_mfma_f32_16x16x32_bf16 v[236:239], v[220:223], v[244:247], v[236:239]
  v_mfma_f32_16x16x32_bf16 v[240:243], v[224:227], v[244:247], v[240:243]
  s_lshl_b32 s21, s20, 8
  s_add_u32 s21, s21, 66560
  v_and_b32 v208, 15, v124
  v_lshlrev_b32 v208, 2, v208
  v_add_u32 v208, s21, v208
  v_lshrrev_b32 v209, 4, v124
  v_lshlrev_b32 v209, 4, v209
  v_add_u32 v209, s21, v209
  ds_write_b32 v208, v96 offset:0
  ds_write_b32 v208, v104 offset:64
  s_mov_b32 exec_lo, 1048577
  s_mov_b32 exec_hi, 268435712
  ds_write_b32 v208, v100 offset:128
  ds_write_b32 v208, v108 offset:192
  s_mov_b32 exec_lo, 2097154
  s_mov_b32 exec_hi, 536871424
  ds_write_b32 v208, v101 offset:128
  ds_write_b32 v208, v109 offset:192
  s_mov_b32 exec_lo, 4194308
  s_mov_b32 exec_hi, 1073742848
  ds_write_b32 v208, v102 offset:128
  ds_write_b32 v208, v110 offset:192
  s_mov_b32 exec_lo, 8388616
  s_mov_b32 exec_hi, 2147485696
  ds_write_b32 v208, v103 offset:128
  ds_write_b32 v208, v111 offset:192
  s_mov_b64 exec, -1
  s_waitcnt lgkmcnt(0)
  ds_read_b128 v[148:151], v209 offset:0
  ds_read_b128 v[152:155], v209 offset:128
  ds_read_b32 v156, v208 offset:0
  ds_read_b32 v157, v208 offset:128
  ds_read_b128 v[160:163], v209 offset:64
  ds_read_b128 v[164:167], v209 offset:192
  ds_read_b32 v168, v208 offset:64
  ds_read_b32 v169, v208 offset:192
  s_waitcnt lgkmcnt(0)
  v_mul_f32 v148, 0x3a800000, v148
  v_mul_f32 v152, 0x3a800000, v152
  v_fma_f32 v152, -v148, v148, v152
  v_max_f32 v152, 0, v152
  v_add_f32 v152, 0x3727c5ac, v152
  v_rsq_f32 v152, v152
  s_nop 0
  v_mul_f32 v148, v148, v152
  v_mul_f32 v149, 0x3a800000, v149
  v_mul_f32 v153, 0x3a800000, v153
  v_fma_f32 v153, -v149, v149, v153
  v_max_f32 v153, 0, v153
  v_add_f32 v153, 0x3727c5ac, v153
  v_rsq_f32 v153, v153
  s_nop 0
  v_mul_f32 v149, v149, v153
  v_mul_f32 v150, 0x3a800000, v150
  v_mul_f32 v154, 0x3a800000, v154
  v_fma_f32 v154, -v150, v150, v154
  v_max_f32 v154, 0, v154
  v_add_f32 v154, 0x3727c5ac, v154
  v_rsq_f32 v154, v154
  s_nop 0
  v_mul_f32 v150, v150, v154
  v_mul_f32 v151, 0x3a800000, v151
  v_mul_f32 v155, 0x3a800000, v155
  v_fma_f32 v155, -v151, v151, v155
  v_max_f32 v155, 0, v155
  v_add_f32 v155, 0x3727c5ac, v155
  v_rsq_f32 v155, v155
  s_nop 0
  v_mul_f32 v151, v151, v155
  v_mul_f32 v156, 0x3a800000, v156
  v_mul_f32 v157, 0x3a800000, v157
  v_fma_f32 v157, -v156, v156, v157
  v_max_f32 v157, 0, v157
  v_add_f32 v157, 0x3727c5ac, v157
  v_rsq_f32 v157, v157
  s_nop 0
  v_mul_f32 v156, v156, v157
  v_mul_f32 v160, 0x3a800000, v160
  v_mul_f32 v164, 0x3a800000, v164
  v_fma_f32 v164, -v160, v160, v164
  v_max_f32 v164, 0, v164
  v_add_f32 v164, 0x3727c5ac, v164
  v_rsq_f32 v164, v164
  s_nop 0
  v_mul_f32 v160, v160, v164
  v_mul_f32 v161, 0x3a800000, v161
  v_mul_f32 v165, 0x3a800000, v165
  v_fma_f32 v165, -v161, v161, v165
  v_max_f32 v165, 0, v165
  v_add_f32 v165, 0x3727c5ac, v165
  v_rsq_f32 v165, v165
  s_nop 0
  v_mul_f32 v161, v161, v165
  v_mul_f32 v162, 0x3a800000, v162
  v_mul_f32 v166, 0x3a800000, v166
  v_fma_f32 v166, -v162, v162, v166
  v_max_f32 v166, 0, v166
  v_add_f32 v166, 0x3727c5ac, v166
  v_rsq_f32 v166, v166
  s_nop 0
  v_mul_f32 v162, v162, v166
  v_mul_f32 v163, 0x3a800000, v163
  v_mul_f32 v167, 0x3a800000, v167
  v_fma_f32 v167, -v163, v163, v167
  v_max_f32 v167, 0, v167
  v_add_f32 v167, 0x3727c5ac, v167
  v_rsq_f32 v167, v167
  s_nop 0
  v_mul_f32 v163, v163, v167
  v_mul_f32 v168, 0x3a800000, v168
  v_mul_f32 v169, 0x3a800000, v169
  v_fma_f32 v169, -v168, v168, v169
  v_max_f32 v169, 0, v169
  v_add_f32 v169, 0x3727c5ac, v169
  v_rsq_f32 v169, v169
  s_nop 0
  v_mul_f32 v168, v168, v169
  s_sub_u32 s21, s21, 65536
  v_subrev_u32 v208, s21, v208
  v_subrev_u32 v209, s21, v209
  s_lshl_b32 s22, s20, 12
  s_add_u32 s22, s22, 69632
  v_add_u32 v212, s22, v125
  ds_write_b128 v212, v[228:231] offset:0
  ds_write_b128 v212, v[232:235] offset:1024
  ds_write_b128 v212, v[236:239] offset:2048
  ds_write_b128 v212, v[240:243] offset:3072
  s_waitcnt lgkmcnt(0)
  s_barrier
  ds_read_b128 v[172:175], v209 offset:0
  ds_read_b128 v[176:179], v209 offset:64
  ds_read_b128 v[180:183], v209 offset:128
  ds_read_b128 v[184:187], v209 offset:192
  ds_read_b32 v188, v208 offset:256
  ds_read_b32 v189, v208 offset:320
  ds_read_b32 v190, v208 offset:384
  ds_read_b32 v191, v208 offset:448
  ds_read_b32 v192, v208 offset:512
  ds_read_b32 v193, v208 offset:576
  ds_read_b32 v194, v208 offset:640
  ds_read_b32 v195, v208 offset:704
  s_waitcnt lgkmcnt(0)
  v_mul_f32 v0, v0, v157
  v_fma_f32 v0, -v156, v172, v0
  v_mul_f32 v1, v1, v157
  v_fma_f32 v1, -v156, v173, v1
  v_mul_f32 v2, v2, v157
  v_fma_f32 v2, -v156, v174, v2
  v_mul_f32 v3, v3, v157
  v_fma_f32 v3, -v156, v175, v3
  v_mul_f32 v4, v4, v157
  v_fma_f32 v4, -v156, v176, v4
  v_mul_f32 v5, v5, v157
  v_fma_f32 v5, -v156, v177, v5
  v_mul_f32 v6, v6, v157
  v_fma_f32 v6, -v156, v178, v6
  v_mul_f32 v7, v7, v157
  v_fma_f32 v7, -v156, v179, v7
  v_mul_f32 v8, v8, v157
  v_fma_f32 v8, -v156, v180, v8
  v_mul_f32 v9, v9, v157
  v_fma_f32 v9, -v156, v181, v9
  v_mul_f32 v10, v10, v157
  v_fma_f32 v10, -v156, v182, v10
  v_mul_f32 v11, v11, v157
  v_fma_f32 v11, -v156, v183, v11
  v_mul_f32 v12, v12, v157
  v_fma_f32 v12, -v156, v184, v12
  v_mul_f32 v13, v13, v157
  v_fma_f32 v13, -v156, v185, v13
  v_mul_f32 v14, v14, v157
  v_fma_f32 v14, -v156, v186, v14
  v_mul_f32 v15, v15, v157
  v_fma_f32 v15, -v156, v187, v15
  v_mul_f32 v16, v16, v152
  v_fma_f32 v16, -v148, v188, v16
  v_mul_f32 v17, v17, v153
  v_fma_f32 v17, -v149, v188, v17
  v_mul_f32 v18, v18, v154
  v_fma_f32 v18, -v150, v188, v18
  v_mul_f32 v19, v19, v155
  v_fma_f32 v19, -v151, v188, v19
  v_mul_f32 v20, v20, v152
  v_fma_f32 v20, -v148, v189, v20
  v_mul_f32 v21, v21, v153
  v_fma_f32 v21, -v149, v189, v21
  v_mul_f32 v22, v22, v154
  v_fma_f32 v22, -v150, v189, v22
  v_mul_f32 v23, v23, v155
  v_fma_f32 v23, -v151, v189, v23
  v_mul_f32 v24, v24, v152
  v_fma_f32 v24, -v148, v190, v24
  v_mul_f32 v25, v25, v153
  v_fma_f32 v25, -v149, v190, v25
  v_mul_f32 v26, v26, v154
  v_fma_f32 v26, -v150, v190, v26
  v_mul_f32 v27, v27, v155
  v_fma_f32 v27, -v151, v190, v27
  v_mul_f32 v28, v28, v152
  v_fma_f32 v28, -v148, v191, v28
  v_mul_f32 v29, v29, v153
  v_fma_f32 v29, -v149, v191, v29
  v_mul_f32 v30, v30, v154
  v_fma_f32 v30, -v150, v191, v30
  v_mul_f32 v31, v31, v155
  v_fma_f32 v31, -v151, v191, v31
  v_mul_f32 v32, v32, v152
  v_fma_f32 v32, -v148, v192, v32
  v_mul_f32 v33, v33, v153
  v_fma_f32 v33, -v149, v192, v33
  v_mul_f32 v34, v34, v154
  v_fma_f32 v34, -v150, v192, v34
  v_mul_f32 v35, v35, v155
  v_fma_f32 v35, -v151, v192, v35
  v_mul_f32 v36, v36, v152
  v_fma_f32 v36, -v148, v193, v36
  v_mul_f32 v37, v37, v153
  v_fma_f32 v37, -v149, v193, v37
  v_mul_f32 v38, v38, v154
  v_fma_f32 v38, -v150, v193, v38
  v_mul_f32 v39, v39, v155
  v_fma_f32 v39, -v151, v193, v39
  v_mul_f32 v40, v40, v152
  v_fma_f32 v40, -v148, v194, v40
  v_mul_f32 v41, v41, v153
  v_fma_f32 v41, -v149, v194, v41
  v_mul_f32 v42, v42, v154
  v_fma_f32 v42, -v150, v194, v42
  v_mul_f32 v43, v43, v155
  v_fma_f32 v43, -v151, v194, v43
  v_mul_f32 v44, v44, v152
  v_fma_f32 v44, -v148, v195, v44
  v_mul_f32 v45, v45, v153
  v_fma_f32 v45, -v149, v195, v45
  v_mul_f32 v46, v46, v154
  v_fma_f32 v46, -v150, v195, v46
  v_mul_f32 v47, v47, v155
  v_fma_f32 v47, -v151, v195, v47
  v_mul_f32 v48, v48, v169
  v_fma_f32 v48, -v168, v172, v48
  v_mul_f32 v49, v49, v169
  v_fma_f32 v49, -v168, v173, v49
  v_mul_f32 v50, v50, v169
  v_fma_f32 v50, -v168, v174, v50
  v_mul_f32 v51, v51, v169
  v_fma_f32 v51, -v168, v175, v51
  v_mul_f32 v52, v52, v169
  v_fma_f32 v52, -v168, v176, v52
  v_mul_f32 v53, v53, v169
  v_fma_f32 v53, -v168, v177, v53
  v_mul_f32 v54, v54, v169
  v_fma_f32 v54, -v168, v178, v54
  v_mul_f32 v55, v55, v169
  v_fma_f32 v55, -v168, v179, v55
  v_mul_f32 v56, v56, v169
  v_fma_f32 v56, -v168, v180, v56
  v_mul_f32 v57, v57, v169
  v_fma_f32 v57, -v168, v181, v57
  v_mul_f32 v58, v58, v169
  v_fma_f32 v58, -v168, v182, v58
  v_mul_f32 v59, v59, v169
  v_fma_f32 v59, -v168, v183, v59
  v_mul_f32 v60, v60, v169
  v_fma_f32 v60, -v168, v184, v60
  v_mul_f32 v61, v61, v169
  v_fma_f32 v61, -v168, v185, v61
  v_mul_f32 v62, v62, v169
  v_fma_f32 v62, -v168, v186, v62
  v_mul_f32 v63, v63, v169
  v_fma_f32 v63, -v168, v187, v63
  v_mul_f32 v64, v64, v164
  v_fma_f32 v64, -v160, v188, v64
  v_mul_f32 v65, v65, v165
  v_fma_f32 v65, -v161, v188, v65
  v_mul_f32 v66, v66, v166
  v_fma_f32 v66, -v162, v188, v66
  v_mul_f32 v67, v67, v167
  v_fma_f32 v67, -v163, v188, v67
  v_mul_f32 v68, v68, v164
  v_fma_f32 v68, -v160, v189, v68
  v_mul_f32 v69, v69, v165
  v_fma_f32 v69, -v161, v189, v69
  v_mul_f32 v70, v70, v166
  v_fma_f32 v70, -v162, v189, v70
  v_mul_f32 v71, v71, v167
  v_fma_f32 v71, -v163, v189, v71
  v_mul_f32 v72, v72, v164
  v_fma_f32 v72, -v160, v190, v72
  v_mul_f32 v73, v73, v165
  v_fma_f32 v73, -v161, v190, v73
  v_mul_f32 v74, v74, v166
  v_fma_f32 v74, -v162, v190, v74
  v_mul_f32 v75, v75, v167
  v_fma_f32 v75, -v163, v190, v75
  v_mul_f32 v76, v76, v164
  v_fma_f32 v76, -v160, v191, v76
  v_mul_f32 v77, v77, v165
  v_fma_f32 v77, -v161, v191, v77
  v_mul_f32 v78, v78, v166
  v_fma_f32 v78, -v162, v191, v78
  v_mul_f32 v79, v79, v167
  v_fma_f32 v79, -v163, v191, v79
  v_mul_f32 v80, v80, v164
  v_fma_f32 v80, -v160, v192, v80
  v_mul_f32 v81, v81, v165
  v_fma_f32 v81, -v161, v192, v81
  v_mul_f32 v82, v82, v166
  v_fma_f32 v82, -v162, v192, v82
  v_mul_f32 v83, v83, v167
  v_fma_f32 v83, -v163, v192, v83
  v_mul_f32 v84, v84, v164
  v_fma_f32 v84, -v160, v193, v84
  v_mul_f32 v85, v85, v165
  v_fma_f32 v85, -v161, v193, v85
  v_mul_f32 v86, v86, v166
  v_fma_f32 v86, -v162, v193, v86
  v_mul_f32 v87, v87, v167
  v_fma_f32 v87, -v163, v193, v87
  v_mul_f32 v88, v88, v164
  v_fma_f32 v88, -v160, v194, v88
  v_mul_f32 v89, v89, v165
  v_fma_f32 v89, -v161, v194, v89
  v_mul_f32 v90, v90, v166
  v_fma_f32 v90, -v162, v194, v90
  v_mul_f32 v91, v91, v167
  v_fma_f32 v91, -v163, v194, v91
  v_mul_f32 v92, v92, v164
  v_fma_f32 v92, -v160, v195, v92
  v_mul_f32 v93, v93, v165
  v_fma_f32 v93, -v161, v195, v93
  v_mul_f32 v94, v94, v166
  v_fma_f32 v94, -v162, v195, v94
  v_mul_f32 v95, v95, v167
  v_fma_f32 v95, -v163, v195, v95
  v_mul_f32 v148, 0x3fb8aa3b, v0
  v_min_f32 v148, 0, v148
  v_exp_f32 v148, v148
  v_max_f32 v0, 0, v0
  v_add_f32 v0, 0x358637bd, v0
  v_add_f32 v0, v0, v148
  v_mul_f32 v149, 0x3fb8aa3b, v1
  v_min_f32 v149, 0, v149
  v_exp_f32 v149, v149
  v_max_f32 v1, 0, v1
  v_add_f32 v1, 0x358637bd, v1
  v_add_f32 v1, v1, v149
  v_mul_f32 v150, 0x3fb8aa3b, v2
  v_min_f32 v150, 0, v150
  v_exp_f32 v150, v150
  v_max_f32 v2, 0, v2
  v_add_f32 v2, 0x358637bd, v2
  v_add_f32 v2, v2, v150
  v_mul_f32 v151, 0x3fb8aa3b, v3
  v_min_f32 v151, 0, v151
  v_exp_f32 v151, v151
  v_max_f32 v3, 0, v3
  v_add_f32 v3, 0x358637bd, v3
  v_add_f32 v3, v3, v151
  v_mul_f32 v148, 0x3fb8aa3b, v4
  v_min_f32 v148, 0, v148
  v_exp_f32 v148, v148
  v_max_f32 v4, 0, v4
  v_add_f32 v4, 0x358637bd, v4
  v_add_f32 v4, v4, v148
  v_mul_f32 v149, 0x3fb8aa3b, v5
  v_min_f32 v149, 0, v149
  v_exp_f32 v149, v149
  v_max_f32 v5, 0, v5
  v_add_f32 v5, 0x358637bd, v5
  v_add_f32 v5, v5, v149
  v_mul_f32 v150, 0x3fb8aa3b, v6
  v_min_f32 v150, 0, v150
  v_exp_f32 v150, v150
  v_max_f32 v6, 0, v6
  v_add_f32 v6, 0x358637bd, v6
  v_add_f32 v6, v6, v150
  v_mul_f32 v151, 0x3fb8aa3b, v7
  v_min_f32 v151, 0, v151
  v_exp_f32 v151, v151
  v_max_f32 v7, 0, v7
  v_add_f32 v7, 0x358637bd, v7
  v_add_f32 v7, v7, v151
  v_mul_f32 v148, 0x3fb8aa3b, v8
  v_min_f32 v148, 0, v148
  v_exp_f32 v148, v148
  v_max_f32 v8, 0, v8
  v_add_f32 v8, 0x358637bd, v8
  v_add_f32 v8, v8, v148
  v_mul_f32 v149, 0x3fb8aa3b, v9
  v_min_f32 v149, 0, v149
  v_exp_f32 v149, v149
  v_max_f32 v9, 0, v9
  v_add_f32 v9, 0x358637bd, v9
  v_add_f32 v9, v9, v149
  v_mul_f32 v150, 0x3fb8aa3b, v10
  v_min_f32 v150, 0, v150
  v_exp_f32 v150, v150
  v_max_f32 v10, 0, v10
  v_add_f32 v10, 0x358637bd, v10
  v_add_f32 v10, v10, v150
  v_mul_f32 v151, 0x3fb8aa3b, v11
  v_min_f32 v151, 0, v151
  v_exp_f32 v151, v151
  v_max_f32 v11, 0, v11
  v_add_f32 v11, 0x358637bd, v11
  v_add_f32 v11, v11, v151
  v_mul_f32 v148, 0x3fb8aa3b, v12
  v_min_f32 v148, 0, v148
  v_exp_f32 v148, v148
  v_max_f32 v12, 0, v12
  v_add_f32 v12, 0x358637bd, v12
  v_add_f32 v12, v12, v148
  v_mul_f32 v149, 0x3fb8aa3b, v13
  v_min_f32 v149, 0, v149
  v_exp_f32 v149, v149
  v_max_f32 v13, 0, v13
  v_add_f32 v13, 0x358637bd, v13
  v_add_f32 v13, v13, v149
  v_mul_f32 v150, 0x3fb8aa3b, v14
  v_min_f32 v150, 0, v150
  v_exp_f32 v150, v150
  v_max_f32 v14, 0, v14
  v_add_f32 v14, 0x358637bd, v14
  v_add_f32 v14, v14, v150
  v_mul_f32 v151, 0x3fb8aa3b, v15
  v_min_f32 v151, 0, v151
  v_exp_f32 v151, v151
  v_max_f32 v15, 0, v15
  v_add_f32 v15, 0x358637bd, v15
  v_add_f32 v15, v15, v151
  v_mul_f32 v148, 0x3fb8aa3b, v16
  v_min_f32 v148, 0, v148
  v_exp_f32 v148, v148
  v_max_f32 v16, 0, v16
  v_add_f32 v16, 0x358637bd, v16
  v_add_f32 v16, v16, v148
  v_mul_f32 v149, 0x3fb8aa3b, v17
  v_min_f32 v149, 0, v149
  v_exp_f32 v149, v149
  v_max_f32 v17, 0, v17
  v_add_f32 v17, 0x358637bd, v17
  v_add_f32 v17, v17, v149
  v_mul_f32 v150, 0x3fb8aa3b, v18
  v_min_f32 v150, 0, v150
  v_exp_f32 v150, v150
  v_max_f32 v18, 0, v18
  v_add_f32 v18, 0x358637bd, v18
  v_add_f32 v18, v18, v150
  v_mul_f32 v151, 0x3fb8aa3b, v19
  v_min_f32 v151, 0, v151
  v_exp_f32 v151, v151
  v_max_f32 v19, 0, v19
  v_add_f32 v19, 0x358637bd, v19
  v_add_f32 v19, v19, v151
  v_mul_f32 v148, 0x3fb8aa3b, v20
  v_min_f32 v148, 0, v148
  v_exp_f32 v148, v148
  v_max_f32 v20, 0, v20
  v_add_f32 v20, 0x358637bd, v20
  v_add_f32 v20, v20, v148
  v_mul_f32 v149, 0x3fb8aa3b, v21
  v_min_f32 v149, 0, v149
  v_exp_f32 v149, v149
  v_max_f32 v21, 0, v21
  v_add_f32 v21, 0x358637bd, v21
  v_add_f32 v21, v21, v149
  v_mul_f32 v150, 0x3fb8aa3b, v22
  v_min_f32 v150, 0, v150
  v_exp_f32 v150, v150
  v_max_f32 v22, 0, v22
  v_add_f32 v22, 0x358637bd, v22
  v_add_f32 v22, v22, v150
  v_mul_f32 v151, 0x3fb8aa3b, v23
  v_min_f32 v151, 0, v151
  v_exp_f32 v151, v151
  v_max_f32 v23, 0, v23
  v_add_f32 v23, 0x358637bd, v23
  v_add_f32 v23, v23, v151
  v_mul_f32 v148, 0x3fb8aa3b, v24
  v_min_f32 v148, 0, v148
  v_exp_f32 v148, v148
  v_max_f32 v24, 0, v24
  v_add_f32 v24, 0x358637bd, v24
  v_add_f32 v24, v24, v148
  v_mul_f32 v149, 0x3fb8aa3b, v25
  v_min_f32 v149, 0, v149
  v_exp_f32 v149, v149
  v_max_f32 v25, 0, v25
  v_add_f32 v25, 0x358637bd, v25
  v_add_f32 v25, v25, v149
  v_mul_f32 v150, 0x3fb8aa3b, v26
  v_min_f32 v150, 0, v150
  v_exp_f32 v150, v150
  v_max_f32 v26, 0, v26
  v_add_f32 v26, 0x358637bd, v26
  v_add_f32 v26, v26, v150
  v_mul_f32 v151, 0x3fb8aa3b, v27
  v_min_f32 v151, 0, v151
  v_exp_f32 v151, v151
  v_max_f32 v27, 0, v27
  v_add_f32 v27, 0x358637bd, v27
  v_add_f32 v27, v27, v151
  v_mul_f32 v148, 0x3fb8aa3b, v28
  v_min_f32 v148, 0, v148
  v_exp_f32 v148, v148
  v_max_f32 v28, 0, v28
  v_add_f32 v28, 0x358637bd, v28
  v_add_f32 v28, v28, v148
  v_mul_f32 v149, 0x3fb8aa3b, v29
  v_min_f32 v149, 0, v149
  v_exp_f32 v149, v149
  v_max_f32 v29, 0, v29
  v_add_f32 v29, 0x358637bd, v29
  v_add_f32 v29, v29, v149
  v_mul_f32 v150, 0x3fb8aa3b, v30
  v_min_f32 v150, 0, v150
  v_exp_f32 v150, v150
  v_max_f32 v30, 0, v30
  v_add_f32 v30, 0x358637bd, v30
  v_add_f32 v30, v30, v150
  v_mul_f32 v151, 0x3fb8aa3b, v31
  v_min_f32 v151, 0, v151
  v_exp_f32 v151, v151
  v_max_f32 v31, 0, v31
  v_add_f32 v31, 0x358637bd, v31
  v_add_f32 v31, v31, v151
  v_mul_f32 v148, 0x3fb8aa3b, v48
  v_min_f32 v148, 0, v148
  v_exp_f32 v148, v148
  v_max_f32 v48, 0, v48
  v_add_f32 v48, 0x358637bd, v48
  v_add_f32 v48, v48, v148
  v_mul_f32 v149, 0x3fb8aa3b, v49
  v_min_f32 v149, 0, v149
  v_exp_f32 v149, v149
  v_max_f32 v49, 0, v49
  v_add_f32 v49, 0x358637bd, v49
  v_add_f32 v49, v49, v149
  v_mul_f32 v150, 0x3fb8aa3b, v50
  v_min_f32 v150, 0, v150
  v_exp_f32 v150, v150
  v_max_f32 v50, 0, v50
  v_add_f32 v50, 0x358637bd, v50
  v_add_f32 v50, v50, v150
  v_mul_f32 v151, 0x3fb8aa3b, v51
  v_min_f32 v151, 0, v151
  v_exp_f32 v151, v151
  v_max_f32 v51, 0, v51
  v_add_f32 v51, 0x358637bd, v51
  v_add_f32 v51, v51, v151
  v_mul_f32 v148, 0x3fb8aa3b, v52
  v_min_f32 v148, 0, v148
  v_exp_f32 v148, v148
  v_max_f32 v52, 0, v52
  v_add_f32 v52, 0x358637bd, v52
  v_add_f32 v52, v52, v148
  v_mul_f32 v149, 0x3fb8aa3b, v53
  v_min_f32 v149, 0, v149
  v_exp_f32 v149, v149
  v_max_f32 v53, 0, v53
  v_add_f32 v53, 0x358637bd, v53
  v_add_f32 v53, v53, v149
  v_mul_f32 v150, 0x3fb8aa3b, v54
  v_min_f32 v150, 0, v150
  v_exp_f32 v150, v150
  v_max_f32 v54, 0, v54
  v_add_f32 v54, 0x358637bd, v54
  v_add_f32 v54, v54, v150
  v_mul_f32 v151, 0x3fb8aa3b, v55
  v_min_f32 v151, 0, v151
  v_exp_f32 v151, v151
  v_max_f32 v55, 0, v55
  v_add_f32 v55, 0x358637bd, v55
  v_add_f32 v55, v55, v151
  v_mul_f32 v148, 0x3fb8aa3b, v56
  v_min_f32 v148, 0, v148
  v_exp_f32 v148, v148
  v_max_f32 v56, 0, v56
  v_add_f32 v56, 0x358637bd, v56
  v_add_f32 v56, v56, v148
  v_mul_f32 v149, 0x3fb8aa3b, v57
  v_min_f32 v149, 0, v149
  v_exp_f32 v149, v149
  v_max_f32 v57, 0, v57
  v_add_f32 v57, 0x358637bd, v57
  v_add_f32 v57, v57, v149
  v_mul_f32 v150, 0x3fb8aa3b, v58
  v_min_f32 v150, 0, v150
  v_exp_f32 v150, v150
  v_max_f32 v58, 0, v58
  v_add_f32 v58, 0x358637bd, v58
  v_add_f32 v58, v58, v150
  v_mul_f32 v151, 0x3fb8aa3b, v59
  v_min_f32 v151, 0, v151
  v_exp_f32 v151, v151
  v_max_f32 v59, 0, v59
  v_add_f32 v59, 0x358637bd, v59
  v_add_f32 v59, v59, v151
  v_mul_f32 v148, 0x3fb8aa3b, v60
  v_min_f32 v148, 0, v148
  v_exp_f32 v148, v148
  v_max_f32 v60, 0, v60
  v_add_f32 v60, 0x358637bd, v60
  v_add_f32 v60, v60, v148
  v_mul_f32 v149, 0x3fb8aa3b, v61
  v_min_f32 v149, 0, v149
  v_exp_f32 v149, v149
  v_max_f32 v61, 0, v61
  v_add_f32 v61, 0x358637bd, v61
  v_add_f32 v61, v61, v149
  v_mul_f32 v150, 0x3fb8aa3b, v62
  v_min_f32 v150, 0, v150
  v_exp_f32 v150, v150
  v_max_f32 v62, 0, v62
  v_add_f32 v62, 0x358637bd, v62
  v_add_f32 v62, v62, v150
  v_mul_f32 v151, 0x3fb8aa3b, v63
  v_min_f32 v151, 0, v151
  v_exp_f32 v151, v151
  v_max_f32 v63, 0, v63
  v_add_f32 v63, 0x358637bd, v63
  v_add_f32 v63, v63, v151
  v_mul_f32 v148, 0x3fb8aa3b, v64
  v_min_f32 v148, 0, v148
  v_exp_f32 v148, v148
  v_max_f32 v64, 0, v64
  v_add_f32 v64, 0x358637bd, v64
  v_add_f32 v64, v64, v148
  v_mul_f32 v149, 0x3fb8aa3b, v65
  v_min_f32 v149, 0, v149
  v_exp_f32 v149, v149
  v_max_f32 v65, 0, v65
  v_add_f32 v65, 0x358637bd, v65
  v_add_f32 v65, v65, v149
  v_mul_f32 v150, 0x3fb8aa3b, v66
  v_min_f32 v150, 0, v150
  v_exp_f32 v150, v150
  v_max_f32 v66, 0, v66
  v_add_f32 v66, 0x358637bd, v66
  v_add_f32 v66, v66, v150
  v_mul_f32 v151, 0x3fb8aa3b, v67
  v_min_f32 v151, 0, v151
  v_exp_f32 v151, v151
  v_max_f32 v67, 0, v67
  v_add_f32 v67, 0x358637bd, v67
  v_add_f32 v67, v67, v151
  v_mul_f32 v148, 0x3fb8aa3b, v68
  v_min_f32 v148, 0, v148
  v_exp_f32 v148, v148
  v_max_f32 v68, 0, v68
  v_add_f32 v68, 0x358637bd, v68
  v_add_f32 v68, v68, v148
  v_mul_f32 v149, 0x3fb8aa3b, v69
  v_min_f32 v149, 0, v149
  v_exp_f32 v149, v149
  v_max_f32 v69, 0, v69
  v_add_f32 v69, 0x358637bd, v69
  v_add_f32 v69, v69, v149
  v_mul_f32 v150, 0x3fb8aa3b, v70
  v_min_f32 v150, 0, v150
  v_exp_f32 v150, v150
  v_max_f32 v70, 0, v70
  v_add_f32 v70, 0x358637bd, v70
  v_add_f32 v70, v70, v150
  v_mul_f32 v151, 0x3fb8aa3b, v71
  v_min_f32 v151, 0, v151
  v_exp_f32 v151, v151
  v_max_f32 v71, 0, v71
  v_add_f32 v71, 0x358637bd, v71
  v_add_f32 v71, v71, v151
  v_mul_f32 v148, 0x3fb8aa3b, v72
  v_min_f32 v148, 0, v148
  v_exp_f32 v148, v148
  v_max_f32 v72, 0, v72
  v_add_f32 v72, 0x358637bd, v72
  v_add_f32 v72, v72, v148
  v_mul_f32 v149, 0x3fb8aa3b, v73
  v_min_f32 v149, 0, v149
  v_exp_f32 v149, v149
  v_max_f32 v73, 0, v73
  v_add_f32 v73, 0x358637bd, v73
  v_add_f32 v73, v73, v149
  v_mul_f32 v150, 0x3fb8aa3b, v74
  v_min_f32 v150, 0, v150
  v_exp_f32 v150, v150
  v_max_f32 v74, 0, v74
  v_add_f32 v74, 0x358637bd, v74
  v_add_f32 v74, v74, v150
  v_mul_f32 v151, 0x3fb8aa3b, v75
  v_min_f32 v151, 0, v151
  v_exp_f32 v151, v151
  v_max_f32 v75, 0, v75
  v_add_f32 v75, 0x358637bd, v75
  v_add_f32 v75, v75, v151
  v_mul_f32 v148, 0x3fb8aa3b, v76
  v_min_f32 v148, 0, v148
  v_exp_f32 v148, v148
  v_max_f32 v76, 0, v76
  v_add_f32 v76, 0x358637bd, v76
  v_add_f32 v76, v76, v148
  v_mul_f32 v149, 0x3fb8aa3b, v77
  v_min_f32 v149, 0, v149
  v_exp_f32 v149, v149
  v_max_f32 v77, 0, v77
  v_add_f32 v77, 0x358637bd, v77
  v_add_f32 v77, v77, v149
  v_mul_f32 v150, 0x3fb8aa3b, v78
  v_min_f32 v150, 0, v150
  v_exp_f32 v150, v150
  v_max_f32 v78, 0, v78
  v_add_f32 v78, 0x358637bd, v78
  v_add_f32 v78, v78, v150
  v_mul_f32 v151, 0x3fb8aa3b, v79
  v_min_f32 v151, 0, v151
  v_exp_f32 v151, v151
  v_max_f32 v79, 0, v79
  v_add_f32 v79, 0x358637bd, v79
  v_add_f32 v79, v79, v151
  s_lshl_b32 s21, s17, 8
  s_add_u32 s21, s21, s18
  s_lshl_b32 s21, s21, 10
  v_cvt_pk_bf16_f32 v148, v0, v1
  v_cvt_pk_bf16_f32 v149, v2, v3
  v_cvt_pk_bf16_f32 v150, v4, v5
  v_cvt_pk_bf16_f32 v151, v6, v7
  buffer_store_dwordx4 v[148:151], v125, s[8:11], s21 offen offset:0 sc0 sc1
  v_cvt_pk_bf16_f32 v152, v48, v49
  v_cvt_pk_bf16_f32 v153, v50, v51
  v_cvt_pk_bf16_f32 v154, v52, v53
  v_cvt_pk_bf16_f32 v155, v54, v55
  buffer_store_dwordx4 v[152:155], v125, s[8:11], s21 offen offset:1024 sc0 sc1
  s_add_u32 s21, s21, 131072
  v_cvt_pk_bf16_f32 v156, v8, v9
  v_cvt_pk_bf16_f32 v157, v10, v11
  v_cvt_pk_bf16_f32 v158, v12, v13
  v_cvt_pk_bf16_f32 v159, v14, v15
  buffer_store_dwordx4 v[156:159], v125, s[8:11], s21 offen offset:0 sc0 sc1
  v_cvt_pk_bf16_f32 v160, v56, v57
  v_cvt_pk_bf16_f32 v161, v58, v59
  v_cvt_pk_bf16_f32 v162, v60, v61
  v_cvt_pk_bf16_f32 v163, v62, v63
  buffer_store_dwordx4 v[160:163], v125, s[8:11], s21 offen offset:1024 sc0 sc1
  s_add_u32 s21, s21, 131072
  v_cvt_pk_bf16_f32 v164, v16, v17
  v_cvt_pk_bf16_f32 v165, v18, v19
  v_cvt_pk_bf16_f32 v166, v64, v65
  v_cvt_pk_bf16_f32 v167, v66, v67
  v_cvt_pk_bf16_f32 v168, v20, v21
  v_cvt_pk_bf16_f32 v169, v22, v23
  v_cvt_pk_bf16_f32 v170, v68, v69
  v_cvt_pk_bf16_f32 v171, v70, v71
  v_cvt_pk_bf16_f32 v172, v24, v25
  v_cvt_pk_bf16_f32 v173, v26, v27
  v_cvt_pk_bf16_f32 v174, v72, v73
  v_cvt_pk_bf16_f32 v175, v74, v75
  v_cvt_pk_bf16_f32 v176, v28, v29
  v_cvt_pk_bf16_f32 v177, v30, v31
  v_cvt_pk_bf16_f32 v178, v76, v77
  v_cvt_pk_bf16_f32 v179, v78, v79
  v_cvt_pk_bf16_f32 v180, v32, v33
  v_cvt_pk_bf16_f32 v181, v34, v35
  v_cvt_pk_bf16_f32 v182, v80, v81
  v_cvt_pk_bf16_f32 v183, v82, v83
  v_cvt_pk_bf16_f32 v184, v36, v37
  v_cvt_pk_bf16_f32 v185, v38, v39
  v_cvt_pk_bf16_f32 v186, v84, v85
  v_cvt_pk_bf16_f32 v187, v86, v87
  v_cvt_pk_bf16_f32 v188, v40, v41
  v_cvt_pk_bf16_f32 v189, v42, v43
  v_cvt_pk_bf16_f32 v190, v88, v89
  v_cvt_pk_bf16_f32 v191, v90, v91
  v_cvt_pk_bf16_f32 v192, v44, v45
  v_cvt_pk_bf16_f32 v193, v46, v47
  v_cvt_pk_bf16_f32 v194, v92, v93
  v_cvt_pk_bf16_f32 v195, v94, v95
  v_mov_b32 v196, 0x3f803f80
  v_mov_b32 v197, 0x3f803f80
  v_mov_b32 v198, 0x3f803f80
  v_mov_b32 v199, 0x3f803f80
  s_nop 1
  v_mfma_f32_16x16x32_bf16 v[0:3], v[164:167], v[180:183], 0
  v_mfma_f32_16x16x32_bf16 v[4:7], v[168:171], v[180:183], 0
  v_mfma_f32_16x16x32_bf16 v[8:11], v[164:167], v[184:187], 0
  v_mfma_f32_16x16x32_bf16 v[12:15], v[168:171], v[184:187], 0
  v_mfma_f32_16x16x32_bf16 v[16:19], v[164:167], v[196:199], 0
  v_mfma_f32_16x16x32_bf16 v[20:23], v[168:171], v[196:199], 0
  v_mfma_f32_16x16x32_bf16 v[24:27], v[172:175], v[188:191], 0
  v_mfma_f32_16x16x32_bf16 v[28:31], v[176:179], v[188:191], 0
  v_mfma_f32_16x16x32_bf16 v[32:35], v[172:175], v[192:195], 0
  v_mfma_f32_16x16x32_bf16 v[36:39], v[176:179], v[192:195], 0
  v_mfma_f32_16x16x32_bf16 v[40:43], v[172:175], v[196:199], 0
  v_mfma_f32_16x16x32_bf16 v[44:47], v[176:179], v[196:199], 0
  s_nop 7
  s_nop 7
  s_mul_i32 s22, s20, 12288
  v_add_u32 v208, s22, v125
  ds_write_b128 v208, v[0:3] offset:0
  ds_write_b128 v208, v[4:7] offset:1024
  ds_write_b128 v208, v[8:11] offset:2048
  ds_write_b128 v208, v[12:15] offset:3072
  ds_write_b128 v208, v[16:19] offset:4096
  ds_write_b128 v208, v[20:23] offset:5120
  ds_write_b128 v208, v[24:27] offset:6144
  ds_write_b128 v208, v[28:31] offset:7168
  ds_write_b128 v208, v[32:35] offset:8192
  ds_write_b128 v208, v[36:39] offset:9216
  ds_write_b128 v208, v[40:43] offset:10240
  ds_write_b128 v208, v[44:47] offset:11264
  s_waitcnt lgkmcnt(0)
  s_barrier
  s_mul_i32 s22, s20, 3072
  v_add_u32 v208, s22, v125
  ds_read_b128 v[0:3], v208 offset:0
  ds_read_b128 v[4:7], v208 offset:1024
  ds_read_b128 v[8:11], v208 offset:2048
  ds_read_b128 v[12:15], v208 offset:12288
  ds_read_b128 v[16:19], v208 offset:13312
  ds_read_b128 v[20:23], v208 offset:14336
  ds_read_b128 v[24:27], v208 offset:24576
  ds_read_b128 v[28:31], v208 offset:25600
  ds_read_b128 v[32:35], v208 offset:26624
  ds_read_b128 v[36:39], v208 offset:36864
  ds_read_b128 v[40:43], v208 offset:37888
  ds_read_b128 v[44:47], v208 offset:38912
  s_waitcnt lgkmcnt(0)
  v_add_f32 v0, v0, v12
  v_add_f32 v1, v1, v13
  v_add_f32 v2, v2, v14
  v_add_f32 v3, v3, v15
  v_add_f32 v4, v4, v16
  v_add_f32 v5, v5, v17
  v_add_f32 v6, v6, v18
  v_add_f32 v7, v7, v19
  v_add_f32 v8, v8, v20
  v_add_f32 v9, v9, v21
  v_add_f32 v10, v10, v22
  v_add_f32 v11, v11, v23
  v_add_f32 v0, v0, v24
  v_add_f32 v1, v1, v25
  v_add_f32 v2, v2, v26
  v_add_f32 v3, v3, v27
  v_add_f32 v4, v4, v28
  v_add_f32 v5, v5, v29
  v_add_f32 v6, v6, v30
  v_add_f32 v7, v7, v31
  v_add_f32 v8, v8, v32
  v_add_f32 v9, v9, v33
  v_add_f32 v10, v10, v34
  v_add_f32 v11, v11, v35
  v_add_f32 v0, v0, v36
  v_add_f32 v1, v1, v37
  v_add_f32 v2, v2, v38
  v_add_f32 v3, v3, v39
  v_add_f32 v4, v4, v40
  v_add_f32 v5, v5, v41
  v_add_f32 v6, v6, v42
  v_add_f32 v7, v7, v43
  v_add_f32 v8, v8, v44
  v_add_f32 v9, v9, v45
  v_add_f32 v10, v10, v46
  v_add_f32 v11, v11, v47
  s_lshr_b32 s21, s20, 1
  s_lshl_b32 s22, s17, 1
  s_add_u32 s21, s21, s22
  s_lshl_b32 s21, s21, 4
  s_add_u32 s21, s21, s16
  s_mul_i32 s21, s21, 6144
  s_and_b32 s22, s20, 1
  s_mul_i32 s22, s22, 3072
  s_add_u32 s21, s21, s22
  buffer_store_dwordx4 v[0:3], v125, s[12:15], s21 offen offset:0 sc0 sc1
  buffer_store_dwordx4 v[4:7], v125, s[12:15], s21 offen offset:1024 sc0 sc1
  buffer_store_dwordx4 v[8:11], v125, s[12:15], s21 offen offset:2048 sc0 sc1
L_gemm1_kernel_end:
  s_endpgm
.globl attn_kernel
.p2align 8
.type attn_kernel,@function
attn_kernel:
  s_cmp_ge_u32 s2, 256
  s_cbranch_scc1 L_attn_kernel_end
  s_load_dwordx2 s[82:83], s[0:1], 72
  s_load_dwordx2 s[76:77], s[0:1], 48
  v_lshrrev_b32 v1, 6, v0
  v_and_b32 v2, 63, v0
  s_nop 0
  v_readfirstlane_b32 s20, v1
  v_lshlrev_b32 v5, 4, v2
  s_and_b32 s16, s2, 31
  s_lshr_b32 s17, s2, 5
  s_waitcnt lgkmcnt(0)
  s_add_u32 s8, s82, 8388608
  s_addc_u32 s9, s83, 0
  s_mov_b32 s10, 3145728
  s_mov_b32 s11, 0x20000
  s_add_u32 s12, s82, 4194304
  s_addc_u32 s13, s83, 0
  s_mov_b32 s14, 4194304
  s_mov_b32 s15, 0x20000
  s_add_u32 s24, s82, 12582912
  s_addc_u32 s25, s83, 0
  s_mov_b32 s26, 4194304
  s_mov_b32 s27, 0x20000
  s_lshl_b32 s21, s16, 4
  s_lshl_b32 s22, s20, 2
  s_add_u32 s21, s21, s22
  s_mul_i32 s21, s21, 6144
  s_add_u32 s23, s21, 0
  buffer_load_dwordx4 v[8:11], v5, s[8:11], s23 offen offset:0
  buffer_load_dwordx4 v[12:15], v5, s[8:11], s23 offen offset:1024
  buffer_load_dwordx4 v[16:19], v5, s[8:11], s23 offen offset:2048
  s_add_u32 s23, s21, 3072
  buffer_load_dwordx4 v[20:23], v5, s[8:11], s23 offen offset:0
  buffer_load_dwordx4 v[24:27], v5, s[8:11], s23 offen offset:1024
  buffer_load_dwordx4 v[28:31], v5, s[8:11], s23 offen offset:2048
  s_add_u32 s23, s21, 6144
  buffer_load_dwordx4 v[32:35], v5, s[8:11], s23 offen offset:0
  buffer_load_dwordx4 v[36:39], v5, s[8:11], s23 offen offset:1024
  buffer_load_dwordx4 v[40:43], v5, s[8:11], s23 offen offset:2048
  s_add_u32 s23, s21, 9216
  buffer_load_dwordx4 v[44:47], v5, s[8:11], s23 offen offset:0
  buffer_load_dwordx4 v[48:51], v5, s[8:11], s23 offen offset:1024
  buffer_load_dwordx4 v[52:55], v5, s[8:11], s23 offen offset:2048
  s_add_u32 s23, s21, 12288
  buffer_load_dwordx4 v[56:59], v5, s[8:11], s23 offen offset:0
  buffer_load_dwordx4 v[60:63], v5, s[8:11], s23 offen offset:1024
  buffer_load_dwordx4 v[64:67], v5, s[8:11], s23 offen offset:2048
  s_add_u32 s23, s21, 15360
  buffer_load_dwordx4 v[68:71], v5, s[8:11], s23 offen offset:0
  buffer_load_dwordx4 v[72:75], v5, s[8:11], s23 offen offset:1024
  buffer_load_dwordx4 v[76:79], v5, s[8:11], s23 offen offset:2048
  s_add_u32 s23, s21, 18432
  buffer_load_dwordx4 v[80:83], v5, s[8:11], s23 offen offset:0
  buffer_load_dwordx4 v[84:87], v5, s[8:11], s23 offen offset:1024
  buffer_load_dwordx4 v[88:91], v5, s[8:11], s23 offen offset:2048
  s_add_u32 s23, s21, 21504
  buffer_load_dwordx4 v[92:95], v5, s[8:11], s23 offen offset:0
  buffer_load_dwordx4 v[96:99], v5, s[8:11], s23 offen offset:1024
  buffer_load_dwordx4 v[100:103], v5, s[8:11], s23 offen offset:2048
  s_lshl_b32 s21, s16, 7
  s_lshl_b32 s22, s17, 4
  s_add_u32 s21, s21, s22
  s_lshl_b32 s22, s20, 2
  s_add_u32 s21, s21, s22
  s_lshl_b32 s21, s21, 10
  buffer_load_dwordx4 v[104:107], v5, s[12:15], s21 offen offset:0
  buffer_load_dwordx4 v[108:111], v5, s[12:15], s21 offen offset:1024
  buffer_load_dwordx4 v[112:115], v5, s[12:15], s21 offen offset:2048
  buffer_load_dwordx4 v[116:119], v5, s[12:15], s21 offen offset:3072
  s_mov_b32 s28, s76
  s_mov_b32 s29, s77
  s_mov_b32 s30, 7340032
  s_mov_b32 s31, 0x20000
  s_lshl_b32 s22, s2, 2
  s_add_u32 s22, s22, s20
  s_mul_i32 s22, s22, 3584
  s_add_u32 s22, s22, 3670016
  v_lshlrev_b32 v6, 7, v2
  s_mov_b64 exec, 0xfffffff
  buffer_load_dword v7, v6, s[28:31], s22 offen
  s_mov_b64 exec, -1
  s_waitcnt vmcnt(5)
  v_add_f32 v8, v8, v32
  v_add_f32 v9, v9, v33
  v_add_f32 v10, v10, v34
  v_add_f32 v11, v11, v35
  v_add_f32 v12, v12, v36
  v_add_f32 v13, v13, v37
  v_add_f32 v14, v14, v38
  v_add_f32 v15, v15, v39
  v_add_f32 v16, v16, v40
  v_add_f32 v17, v17, v41
  v_add_f32 v18, v18, v42
  v_add_f32 v19, v19, v43
  v_add_f32 v20, v20, v44
  v_add_f32 v21, v21, v45
  v_add_f32 v22, v22, v46
  v_add_f32 v23, v23, v47
  v_add_f32 v24, v24, v48
  v_add_f32 v25, v25, v49
  v_add_f32 v26, v26, v50
  v_add_f32 v27, v27, v51
  v_add_f32 v28, v28, v52
  v_add_f32 v29, v29, v53
  v_add_f32 v30, v30, v54
  v_add_f32 v31, v31, v55
  v_add_f32 v8, v8, v56
  v_add_f32 v9, v9, v57
  v_add_f32 v10, v10, v58
  v_add_f32 v11, v11, v59
  v_add_f32 v12, v12, v60
  v_add_f32 v13, v13, v61
  v_add_f32 v14, v14, v62
  v_add_f32 v15, v15, v63
  v_add_f32 v16, v16, v64
  v_add_f32 v17, v17, v65
  v_add_f32 v18, v18, v66
  v_add_f32 v19, v19, v67
  v_add_f32 v20, v20, v68
  v_add_f32 v21, v21, v69
  v_add_f32 v22, v22, v70
  v_add_f32 v23, v23, v71
  v_add_f32 v24, v24, v72
  v_add_f32 v25, v25, v73
  v_add_f32 v26, v26, v74
  v_add_f32 v27, v27, v75
  v_add_f32 v28, v28, v76
  v_add_f32 v29, v29, v77
  v_add_f32 v30, v30, v78
  v_add_f32 v31, v31, v79
  v_add_f32 v8, v8, v80
  v_add_f32 v9, v9, v81
  v_add_f32 v10, v10, v82
  v_add_f32 v11, v11, v83
  v_add_f32 v12, v12, v84
  v_add_f32 v13, v13, v85
  v_add_f32 v14, v14, v86
  v_add_f32 v15, v15, v87
  v_add_f32 v16, v16, v88
  v_add_f32 v17, v17, v89
  v_add_f32 v18, v18, v90
  v_add_f32 v19, v19, v91
  v_add_f32 v20, v20, v92
  v_add_f32 v21, v21, v93
  v_add_f32 v22, v22, v94
  v_add_f32 v23, v23, v95
  v_add_f32 v24, v24, v96
  v_add_f32 v25, v25, v97
  v_add_f32 v26, v26, v98
  v_add_f32 v27, v27, v99
  v_add_f32 v28, v28, v100
  v_add_f32 v29, v29, v101
  v_add_f32 v30, v30, v102
  v_add_f32 v31, v31, v103
  s_mul_i32 s22, s20, 6144
  v_add_u32 v6, s22, v5
  ds_write_b128 v6, v[8:11] offset:0
  ds_write_b128 v6, v[12:15] offset:1024
  ds_write_b128 v6, v[16:19] offset:2048
  ds_write_b128 v6, v[20:23] offset:3072
  ds_write_b128 v6, v[24:27] offset:4096
  ds_write_b128 v6, v[28:31] offset:5120
  s_waitcnt lgkmcnt(0)
  s_barrier
  ds_read_b128 v[8:11], v5 offset:0
  ds_read_b128 v[12:15], v5 offset:1024
  ds_read_b128 v[16:19], v5 offset:2048
  ds_read_b128 v[20:23], v5 offset:3072
  ds_read_b128 v[24:27], v5 offset:4096
  ds_read_b128 v[28:31], v5 offset:5120
  ds_read_b128 v[32:35], v5 offset:6144
  ds_read_b128 v[36:39], v5 offset:7168
  ds_read_b128 v[40:43], v5 offset:8192
  ds_read_b128 v[44:47], v5 offset:9216
  ds_read_b128 v[48:51], v5 offset:10240
  ds_read_b128 v[52:55], v5 offset:11264
  ds_read_b128 v[56:59], v5 offset:12288
  ds_read_b128 v[60:63], v5 offset:13312
  ds_read_b128 v[64:67], v5 offset:14336
  ds_read_b128 v[68:71], v5 offset:15360
  ds_read_b128 v[72:75], v5 offset:16384
  ds_read_b128 v[76:79], v5 offset:17408
  ds_read_b128 v[80:83], v5 offset:18432
  ds_read_b128 v[84:87], v5 offset:19456
  ds_read_b128 v[88:91], v5 offset:20480
  ds_read_b128 v[92:95], v5 offset:21504
  ds_read_b128 v[96:99], v5 offset:22528
  ds_read_b128 v[100:103], v5 offset:23552
  s_waitcnt lgkmcnt(0)
  v_add_f32 v8, v8, v32
  v_add_f32 v9, v9, v33
  v_add_f32 v10, v10, v34
  v_add_f32 v11, v11, v35
  v_add_f32 v12, v12, v36
  v_add_f32 v13, v13, v37
  v_add_f32 v14, v14, v38
  v_add_f32 v15, v15, v39
  v_add_f32 v16, v16, v40
  v_add_f32 v17, v17, v41
  v_add_f32 v18, v18, v42
  v_add_f32 v19, v19, v43
  v_add_f32 v20, v20, v44
  v_add_f32 v21, v21, v45
  v_add_f32 v22, v22, v46
  v_add_f32 v23, v23, v47
  v_add_f32 v24, v24, v48
  v_add_f32 v25, v25, v49
  v_add_f32 v26, v26, v50
  v_add_f32 v27, v27, v51
  v_add_f32 v28, v28, v52
  v_add_f32 v29, v29, v53
  v_add_f32 v30, v30, v54
  v_add_f32 v31, v31, v55
  v_add_f32 v8, v8, v56
  v_add_f32 v9, v9, v57
  v_add_f32 v10, v10, v58
  v_add_f32 v11, v11, v59
  v_add_f32 v12, v12, v60
  v_add_f32 v13, v13, v61
  v_add_f32 v14, v14, v62
  v_add_f32 v15, v15, v63
  v_add_f32 v16, v16, v64
  v_add_f32 v17, v17, v65
  v_add_f32 v18, v18, v66
  v_add_f32 v19, v19, v67
  v_add_f32 v20, v20, v68
  v_add_f32 v21, v21, v69
  v_add_f32 v22, v22, v70
  v_add_f32 v23, v23, v71
  v_add_f32 v24, v24, v72
  v_add_f32 v25, v25, v73
  v_add_f32 v26, v26, v74
  v_add_f32 v27, v27, v75
  v_add_f32 v28, v28, v76
  v_add_f32 v29, v29, v77
  v_add_f32 v30, v30, v78
  v_add_f32 v31, v31, v79
  v_add_f32 v8, v8, v80
  v_add_f32 v9, v9, v81
  v_add_f32 v10, v10, v82
  v_add_f32 v11, v11, v83
  v_add_f32 v12, v12, v84
  v_add_f32 v13, v13, v85
  v_add_f32 v14, v14, v86
  v_add_f32 v15, v15, v87
  v_add_f32 v16, v16, v88
  v_add_f32 v17, v17, v89
  v_add_f32 v18, v18, v90
  v_add_f32 v19, v19, v91
  v_add_f32 v20, v20, v92
  v_add_f32 v21, v21, v93
  v_add_f32 v22, v22, v94
  v_add_f32 v23, v23, v95
  v_add_f32 v24, v24, v96
  v_add_f32 v25, v25, v97
  v_add_f32 v26, v26, v98
  v_add_f32 v27, v27, v99
  v_add_f32 v28, v28, v100
  v_add_f32 v29, v29, v101
  v_add_f32 v30, v30, v102
  v_add_f32 v31, v31, v103
  v_cvt_pk_bf16_f32 v32, v8, v9
  v_cvt_pk_bf16_f32 v33, v10, v11
  v_cvt_pk_bf16_f32 v34, v12, v13
  v_cvt_pk_bf16_f32 v35, v14, v15
  v_cvt_pk_bf16_f32 v36, v16, v17
  v_cvt_pk_bf16_f32 v37, v18, v19
  v_cvt_pk_bf16_f32 v38, v20, v21
  v_cvt_pk_bf16_f32 v39, v22, v23
  v_cvt_pk_bf16_f32 v40, v24, v25
  v_cvt_pk_bf16_f32 v41, v26, v27
  v_cvt_pk_bf16_f32 v42, v28, v29
  v_cvt_pk_bf16_f32 v43, v30, v31
  s_waitcnt vmcnt(1)
  s_nop 1
  v_mfma_f32_16x16x32_bf16 v[48:51], v[32:35], v[104:107], 0
  v_mfma_f32_16x16x32_bf16 v[52:55], v[36:39], v[104:107], 0
  v_mfma_f32_16x16x32_bf16 v[56:59], v[40:43], v[104:107], 0
  v_mfma_f32_16x16x32_bf16 v[60:63], v[32:35], v[108:111], 0
  v_mfma_f32_16x16x32_bf16 v[64:67], v[36:39], v[108:111], 0
  v_mfma_f32_16x16x32_bf16 v[68:71], v[40:43], v[108:111], 0
  v_mfma_f32_16x16x32_bf16 v[72:75], v[32:35], v[112:115], 0
  v_mfma_f32_16x16x32_bf16 v[76:79], v[36:39], v[112:115], 0
  v_mfma_f32_16x16x32_bf16 v[80:83], v[40:43], v[112:115], 0
  v_mfma_f32_16x16x32_bf16 v[84:87], v[32:35], v[116:119], 0
  v_mfma_f32_16x16x32_bf16 v[88:91], v[36:39], v[116:119], 0
  v_mfma_f32_16x16x32_bf16 v[92:95], v[40:43], v[116:119], 0
  s_nop 7
  s_nop 7
  v_add_f32 v56, 0x358637bd, v56
  v_rcp_f32 v56, v56
  s_nop 0
  v_mul_f32 v48, v48, v56
  v_mul_f32 v49, v49, v56
  v_mul_f32 v50, v50, v56
  v_mul_f32 v51, v51, v56
  v_mul_f32 v52, v52, v56
  v_mul_f32 v53, v53, v56
  v_mul_f32 v54, v54, v56
  v_mul_f32 v55, v55, v56
  v_cvt_pk_bf16_f32 v8, v48, v49
  v_cvt_pk_bf16_f32 v9, v50, v51
  v_cvt_pk_bf16_f32 v10, v52, v53
  v_cvt_pk_bf16_f32 v11, v54, v55
  buffer_store_dwordx4 v[8:11], v5, s[24:27], s21 offen offset:0 sc0 sc1
  v_add_f32 v68, 0x358637bd, v68
  v_rcp_f32 v68, v68
  s_nop 0
  v_mul_f32 v60, v60, v68
  v_mul_f32 v61, v61, v68
  v_mul_f32 v62, v62, v68
  v_mul_f32 v63, v63, v68
  v_mul_f32 v64, v64, v68
  v_mul_f32 v65, v65, v68
  v_mul_f32 v66, v66, v68
  v_mul_f32 v67, v67, v68
  v_cvt_pk_bf16_f32 v12, v60, v61
  v_cvt_pk_bf16_f32 v13, v62, v63
  v_cvt_pk_bf16_f32 v14, v64, v65
  v_cvt_pk_bf16_f32 v15, v66, v67
  buffer_store_dwordx4 v[12:15], v5, s[24:27], s21 offen offset:1024 sc0 sc1
  v_add_f32 v80, 0x358637bd, v80
  v_rcp_f32 v80, v80
  s_nop 0
  v_mul_f32 v72, v72, v80
  v_mul_f32 v73, v73, v80
  v_mul_f32 v74, v74, v80
  v_mul_f32 v75, v75, v80
  v_mul_f32 v76, v76, v80
  v_mul_f32 v77, v77, v80
  v_mul_f32 v78, v78, v80
  v_mul_f32 v79, v79, v80
  v_cvt_pk_bf16_f32 v16, v72, v73
  v_cvt_pk_bf16_f32 v17, v74, v75
  v_cvt_pk_bf16_f32 v18, v76, v77
  v_cvt_pk_bf16_f32 v19, v78, v79
  buffer_store_dwordx4 v[16:19], v5, s[24:27], s21 offen offset:2048 sc0 sc1
  v_add_f32 v92, 0x358637bd, v92
  v_rcp_f32 v92, v92
  s_nop 0
  v_mul_f32 v84, v84, v92
  v_mul_f32 v85, v85, v92
  v_mul_f32 v86, v86, v92
  v_mul_f32 v87, v87, v92
  v_mul_f32 v88, v88, v92
  v_mul_f32 v89, v89, v92
  v_mul_f32 v90, v90, v92
  v_mul_f32 v91, v91, v92
  v_cvt_pk_bf16_f32 v20, v84, v85
  v_cvt_pk_bf16_f32 v21, v86, v87
  v_cvt_pk_bf16_f32 v22, v88, v89
  v_cvt_pk_bf16_f32 v23, v90, v91
  buffer_store_dwordx4 v[20:23], v5, s[24:27], s21 offen offset:3072 sc0 sc1
L_attn_kernel_end:
  s_endpgm
.globl gemm2_kernel
.p2align 8
.type gemm2_kernel,@function
gemm2_kernel:
  s_cmp_ge_u32 s2, 256
  s_cbranch_scc1 L_gemm2_kernel_end
  s_load_dwordx16 s[64:79], s[0:1], 0
  s_load_dwordx4 s[80:83], s[0:1], 64
  v_lshrrev_b32 v35, 6, v0
  v_and_b32 v32, 63, v0
  s_nop 0
  v_readfirstlane_b32 s20, v35
  s_and_b32 s21, s2, 7
  s_lshr_b32 s22, s2, 3
  s_and_b32 s23, s21, 1
  s_lshr_b32 s24, s21, 1
  s_and_b32 s26, s22, 3
  s_lshr_b32 s25, s22, 2
  s_mul_i32 s23, s23, 8
  s_add_u32 s17, s23, s25
  s_mul_i32 s24, s24, 4
  s_add_u32 s16, s24, s26
  v_lshlrev_b32 v33, 4, v32
  v_lshrrev_b32 v35, 5, v32
  v_mul_u32_u24 v34, 2048, v35
  v_bfe_u32 v36, v32, 2, 3
  v_lshl_add_u32 v34, v36, 7, v34
  v_lshrrev_b32 v36, 1, v36
  v_lshl_add_u32 v34, v36, 5, v34
  v_and_b32 v35, 3, v32
  v_lshl_add_u32 v34, v35, 3, v34
  s_sub_u32 s19, s20, 4
  s_max_i32 s19, s19, 0
  s_min_i32 s19, s19, 3
  s_mul_i32 s27, s19, 2
  s_and_b32 s28, s17, 7
  s_mov_b32 s56, 2048
  s_cmp_eq_u32 s28, 3
  s_cselect_b32 s56, 128, s56
  s_lshl_b32 s57, s56, 6
  v_lshrrev_b32 v37, 4, v32
  v_bfe_u32 v36, v32, 1, 2
  v_xor_b32 v36, v36, v37
  v_lshrrev_b32 v35, 5, v32
  v_mul_u32_u24 v35, 4, v35
  v_bfe_u32 v37, v32, 3, 2
  v_add_u32 v35, v35, v37
  v_mul_u32_u24 v35, s56, v35
  v_lshl_add_u32 v35, v36, 5, v35
  v_and_b32 v37, 1, v32
  v_lshl_add_u32 v35, v37, 4, v35
  s_add_u32 s28, s27, 0
  s_mul_i32 s29, s28, 65536
  s_lshr_b32 s29, s29, 16
  s_mul_i32 s30, s29, 1
  s_sub_u32 s28, s28, s30
  s_lshr_b32 s30, s29, 2
  s_mul_i32 s30, s30, 32
  s_bfe_u32 s31, s29, 0x10001
  s_mul_i32 s31, s31, 8
  s_add_u32 s30, s30, s31
  s_and_b32 s31, s29, 1
  s_mul_i32 s31, s31, 16
  s_add_u32 s30, s30, s31
  s_mul_i32 s30, s30, s56
  s_mul_i32 s31, s28, 128
  s_add_u32 s30, s30, s31
  v_add_u32 v48, s30, v35
  s_add_u32 s28, s27, 1
  s_mul_i32 s29, s28, 65536
  s_lshr_b32 s29, s29, 16
  s_mul_i32 s30, s29, 1
  s_sub_u32 s28, s28, s30
  s_lshr_b32 s30, s29, 2
  s_mul_i32 s30, s30, 32
  s_bfe_u32 s31, s29, 0x10001
  s_mul_i32 s31, s31, 8
  s_add_u32 s30, s30, s31
  s_and_b32 s31, s29, 1
  s_mul_i32 s31, s31, 16
  s_add_u32 s30, s30, s31
  s_mul_i32 s30, s30, s56
  s_mul_i32 s31, s28, 128
  s_add_u32 s30, s30, s31
  v_add_u32 v49, s30, v35
  s_waitcnt lgkmcnt(0)
  s_add_u32 s8, s82, 12582912
  s_addc_u32 s9, s83, 0
  s_mov_b32 s10, 4194304
  s_mov_b32 s11, 0x20000
  s_add_u32 s28, s27, 0
  s_mov_b32 s40, s68
  s_mov_b32 s41, s69
  s_cmp_ge_u32 s28, 8
  s_cselect_b32 s42, 0, 2097152
  s_mov_b32 s43, 0x20000
  s_add_u32 s28, s82, 23068672
  s_addc_u32 s29, s83, 0
  s_cmp_eq_u32 s56, 128
  s_cselect_b32 s40, s28, s40
  s_cselect_b32 s41, s29, s41
  s_cselect_b32 s42, 262144, s42
  s_mul_i32 s32, s16, 8
  s_mul_i32 s28, s20, 2
  s_add_u32 s18, s32, s28
  s_lshl_b32 s32, s18, 10
  s_mul_i32 s33, s17, 128
  s_lshr_b32 s28, s17, 3
  s_mul_i32 s28, s28, 131072
  s_cmp_eq_u32 s56, 128
  s_cselect_b32 s33, s28, s33
  s_lshl_b32 s39, s27, 10
  s_mov_b32 s37, 0
  s_mov_b32 s35, 0
  s_mov_b32 s38, 0x7ff00000
  s_cmp_lt_u32 s20, 4
  s_cbranch_scc1 L_gemm2_kernel_comp
  s_add_u32 s36, s37, s39
  s_add_u32 s37, s37, 8192
  s_cmp_eq_u32 s37, 49152
  s_cselect_b32 s37, 0, s37
  s_add_u32 m0, s36, 0
  s_nop 0
  buffer_load_dwordx4 v48, s[40:43], s33 offen lds
  s_add_u32 m0, s36, 1024
  s_nop 0
  buffer_load_dwordx4 v49, s[40:43], s33 offen lds
  s_add_u32 s33, s33, s57
  s_add_u32 s36, s37, s39
  s_add_u32 s37, s37, 8192
  s_cmp_eq_u32 s37, 49152
  s_cselect_b32 s37, 0, s37
  s_add_u32 m0, s36, 0
  s_nop 0
  buffer_load_dwordx4 v48, s[40:43], s33 offen lds
  s_add_u32 m0, s36, 1024
  s_nop 0
  buffer_load_dwordx4 v49, s[40:43], s33 offen lds
  s_add_u32 s33, s33, s57
  s_add_u32 s36, s37, s39
  s_add_u32 s37, s37, 8192
  s_cmp_eq_u32 s37, 49152
  s_cselect_b32 s37, 0, s37
  s_add_u32 m0, s36, 0
  s_nop 0
  buffer_load_dwordx4 v48, s[40:43], s33 offen lds
  s_add_u32 m0, s36, 1024
  s_nop 0
  buffer_load_dwordx4 v49, s[40:43], s33 offen lds
  s_add_u32 s33, s33, s57
  s_add_u32 s36, s37, s39
  s_add_u32 s37, s37, 8192
  s_cmp_eq_u32 s37, 49152
  s_cselect_b32 s37, 0, s37
  s_add_u32 m0, s36, 0
  s_nop 0
  buffer_load_dwordx4 v48, s[40:43], s33 offen lds
  s_add_u32 m0, s36, 1024
  s_nop 0
  buffer_load_dwordx4 v49, s[40:43], s33 offen lds
  s_add_u32 s33, s33, s57
  s_waitcnt vmcnt(6)
  s_barrier
  s_add_u32 s36, s37, s39
  s_add_u32 s37, s37, 8192
  s_cmp_eq_u32 s37, 49152
  s_cselect_b32 s37, 0, s37
  s_add_u32 m0, s36, 0
  s_nop 0
  buffer_load_dwordx4 v48, s[40:43], s33 offen lds
  s_add_u32 m0, s36, 1024
  s_nop 0
  buffer_load_dwordx4 v49, s[40:43], s33 offen lds
  s_add_u32 s33, s33, s57
  s_mov_b32 s34, 11
L_gemm2_kernel_lloop:
  s_waitcnt vmcnt(6)
  s_barrier
  s_add_u32 s36, s37, s39
  s_add_u32 s37, s37, 8192
  s_cmp_eq_u32 s37, 49152
  s_cselect_b32 s37, 0, s37
  s_add_u32 m0, s36, 0
  s_nop 0
  buffer_load_dwordx4 v48, s[40:43], s33 offen lds
  s_add_u32 m0, s36, 1024
  s_nop 0
  buffer_load_dwordx4 v49, s[40:43], s33 offen lds
  s_add_u32 s33, s33, s57
  s_sub_u32 s34, s34, 1
  s_cmp_lg_u32 s34, 0
  s_cbranch_scc1 L_gemm2_kernel_lloop
  s_mov_b32 s4, s64
  s_mov_b32 s5, s65
  s_mov_b32 s6, 4194304
  s_mov_b32 s7, 0x20000
  v_lshrrev_b32 v35, 3, v32
  v_and_b32 v36, 7, v32
  v_xor_b32 v36, v36, v35
  v_lshlrev_b32 v35, 11, v35
  v_lshl_add_u32 v35, v36, 4, v35
  s_lshl_b32 s3, s16, 2
  s_add_u32 s3, s3, s19
  s_lshl_b32 s3, s3, 16
  s_lshl_b32 s28, s17, 7
  s_add_u32 s3, s3, s28
  s_lshl_b32 s28, s19, 12
  s_add_u32 s28, s28, 49152
  s_add_u32 m0, s28, 0
  s_nop 0
  buffer_load_dwordx4 v35, s[4:7], s3 offen lds
  s_add_u32 s3, s3, 16384
  s_add_u32 m0, s28, 1024
  s_nop 0
  buffer_load_dwordx4 v35, s[4:7], s3 offen lds
  s_add_u32 s3, s3, 16384
  s_add_u32 m0, s28, 2048
  s_nop 0
  buffer_load_dwordx4 v35, s[4:7], s3 offen lds
  s_add_u32 s3, s3, 16384
  s_add_u32 m0, s28, 3072
  s_nop 0
  buffer_load_dwordx4 v35, s[4:7], s3 offen lds
  s_add_u32 s3, s3, 16384
  s_waitcnt vmcnt(10)
  s_barrier
  s_waitcnt vmcnt(8)
  s_barrier
  s_waitcnt vmcnt(6)
  s_barrier
  s_waitcnt vmcnt(4)
  s_barrier
  s_waitcnt vmcnt(0)
  s_barrier
  s_waitcnt lgkmcnt(0)
  s_branch L_gemm2_kernel_end
L_gemm2_kernel_comp:
  buffer_load_dwordx4 v[108:111], v33, s[8:11], s38 offen offset:0
  buffer_load_dwordx4 v[112:115], v33, s[8:11], s38 offen offset:1024
  buffer_load_dwordx4 v[52:55], v33, s[8:11], s32 offen offset:0
  buffer_load_dwordx4 v[56:59], v33, s[8:11], s32 offen offset:1024
  s_add_u32 s32, s32, 131072
  buffer_load_dwordx4 v[60:63], v33, s[8:11], s32 offen offset:0
  buffer_load_dwordx4 v[64:67], v33, s[8:11], s32 offen offset:1024
  s_add_u32 s32, s32, 131072
  buffer_load_dwordx4 v[68:71], v33, s[8:11], s32 offen offset:0
  buffer_load_dwordx4 v[72:75], v33, s[8:11], s32 offen offset:1024
  s_add_u32 s32, s32, 131072
  buffer_load_dwordx4 v[76:79], v33, s[8:11], s32 offen offset:0
  buffer_load_dwordx4 v[80:83], v33, s[8:11], s32 offen offset:1024
  s_add_u32 s32, s32, 131072
  buffer_load_dwordx4 v[84:87], v33, s[8:11], s32 offen offset:0
  buffer_load_dwordx4 v[88:91], v33, s[8:11], s32 offen offset:1024
  s_add_u32 s32, s32, 131072
  buffer_load_dwordx4 v[92:95], v33, s[8:11], s32 offen offset:0
  v_mov_b32 v0, 0
  v_mov_b32 v1, 0
  v_mov_b32 v2, 0
  v_mov_b32 v3, 0
  v_mov_b32 v4, 0
  v_mov_b32 v5, 0
  v_mov_b32 v6, 0
  v_mov_b32 v7, 0
  v_mov_b32 v8, 0
  v_mov_b32 v9, 0
  v_mov_b32 v10, 0
  v_mov_b32 v11, 0
  v_mov_b32 v12, 0
  v_mov_b32 v13, 0
  v_mov_b32 v14, 0
  v_mov_b32 v15, 0
  v_mov_b32 v16, 0
  v_mov_b32 v17, 0
  v_mov_b32 v18, 0
  v_mov_b32 v19, 0
  v_mov_b32 v20, 0
  v_mov_b32 v21, 0
  v_mov_b32 v22, 0
  v_mov_b32 v23, 0
  v_mov_b32 v24, 0
  v_mov_b32 v25, 0
  v_mov_b32 v26, 0
  v_mov_b32 v27, 0
  v_mov_b32 v28, 0
  v_mov_b32 v29, 0
  v_mov_b32 v30, 0
  v_mov_b32 v31, 0
  s_barrier
  v_add_u32 v40, s35, v34
  v_xor_b32 v41, 32, v40
  v_xor_b32 v42, 64, v40
  v_xor_b32 v43, 96, v40
  s_add_u32 s35, s35, 8192
  s_cmp_eq_u32 s35, 49152
  s_cselect_b32 s35, 0, s35
  ds_read_b64_tr_b16 v[116:117], v40 offset:0
  ds_read_b64_tr_b16 v[118:119], v40 offset:1024
  buffer_load_dwordx4 v[96:99], v33, s[8:11], s32 offen offset:1024
  s_add_u32 s32, s32, 131072
  ds_read_b64_tr_b16 v[120:121], v41 offset:0
  ds_read_b64_tr_b16 v[122:123], v41 offset:1024
  ds_read_b64_tr_b16 v[124:125], v42 offset:0
  ds_read_b64_tr_b16 v[126:127], v42 offset:1024
  buffer_load_dwordx4 v[100:103], v33, s[8:11], s32 offen offset:0
  ds_read_b64_tr_b16 v[128:129], v43 offset:0
  ds_read_b64_tr_b16 v[130:131], v43 offset:1024
  ds_read_b64_tr_b16 v[132:133], v40 offset:4096
  ds_read_b64_tr_b16 v[134:135], v40 offset:5120
  buffer_load_dwordx4 v[104:107], v33, s[8:11], s32 offen offset:1024
  s_add_u32 s32, s32, 131072
  ds_read_b64_tr_b16 v[136:137], v41 offset:4096
  ds_read_b64_tr_b16 v[138:139], v41 offset:5120
  s_mov_b32 s34, 4
L_gemm2_kernel_loop0:
  ds_read_b64_tr_b16 v[140:141], v42 offset:4096
  ds_read_b64_tr_b16 v[142:143], v42 offset:5120
  s_waitcnt vmcnt(12)
  s_waitcnt lgkmcnt(12)
  v_mfma_f32_16x16x32_bf16 v[0:3], v[116:119], v[52:55], v[0:3]
  buffer_load_dwordx4 v[108:111], v33, s[8:11], s32 offen offset:0
  v_mfma_f32_16x16x32_bf16 v[16:19], v[116:119], v[56:59], v[16:19]
  ds_read_b64_tr_b16 v[144:145], v43 offset:4096
  ds_read_b64_tr_b16 v[146:147], v43 offset:5120
  s_waitcnt lgkmcnt(12)
  v_mfma_f32_16x16x32_bf16 v[4:7], v[120:123], v[52:55], v[4:7]
  v_mfma_f32_16x16x32_bf16 v[20:23], v[120:123], v[56:59], v[20:23]
  s_barrier
  v_add_u32 v44, s35, v34
  v_xor_b32 v45, 32, v44
  v_xor_b32 v46, 64, v44
  v_xor_b32 v47, 96, v44
  s_add_u32 s35, s35, 8192
  s_cmp_eq_u32 s35, 49152
  s_cselect_b32 s35, 0, s35
  ds_read_b64_tr_b16 v[116:117], v44 offset:0
  ds_read_b64_tr_b16 v[118:119], v44 offset:1024
  s_waitcnt lgkmcnt(12)
  v_mfma_f32_16x16x32_bf16 v[8:11], v[124:127], v[52:55], v[8:11]
  buffer_load_dwordx4 v[112:115], v33, s[8:11], s32 offen offset:1024
  s_add_u32 s32, s32, 131072
  v_mfma_f32_16x16x32_bf16 v[24:27], v[124:127], v[56:59], v[24:27]
  ds_read_b64_tr_b16 v[120:121], v45 offset:0
  ds_read_b64_tr_b16 v[122:123], v45 offset:1024
  s_waitcnt lgkmcnt(12)
  v_mfma_f32_16x16x32_bf16 v[12:15], v[128:131], v[52:55], v[12:15]
  v_mfma_f32_16x16x32_bf16 v[28:31], v[128:131], v[56:59], v[28:31]
  ds_read_b64_tr_b16 v[124:125], v46 offset:0
  ds_read_b64_tr_b16 v[126:127], v46 offset:1024
  s_waitcnt vmcnt(12)
  s_waitcnt lgkmcnt(12)
  v_mfma_f32_16x16x32_bf16 v[0:3], v[132:135], v[60:63], v[0:3]
  buffer_load_dwordx4 v[52:55], v33, s[8:11], s32 offen offset:0
  v_mfma_f32_16x16x32_bf16 v[16:19], v[132:135], v[64:67], v[16:19]
  ds_read_b64_tr_b16 v[128:129], v47 offset:0
  ds_read_b64_tr_b16 v[130:131], v47 offset:1024
  s_waitcnt lgkmcnt(12)
  v_mfma_f32_16x16x32_bf16 v[4:7], v[136:139], v[60:63], v[4:7]
  v_mfma_f32_16x16x32_bf16 v[20:23], v[136:139], v[64:67], v[20:23]
  ds_read_b64_tr_b16 v[132:133], v44 offset:4096
  ds_read_b64_tr_b16 v[134:135], v44 offset:5120
  s_waitcnt lgkmcnt(12)
  v_mfma_f32_16x16x32_bf16 v[8:11], v[140:143], v[60:63], v[8:11]
  buffer_load_dwordx4 v[56:59], v33, s[8:11], s32 offen offset:1024
  s_add_u32 s32, s32, 131072
  v_mfma_f32_16x16x32_bf16 v[24:27], v[140:143], v[64:67], v[24:27]
  ds_read_b64_tr_b16 v[136:137], v45 offset:4096
  ds_read_b64_tr_b16 v[138:139], v45 offset:5120
  s_waitcnt lgkmcnt(12)
  v_mfma_f32_16x16x32_bf16 v[12:15], v[144:147], v[60:63], v[12:15]
  v_mfma_f32_16x16x32_bf16 v[28:31], v[144:147], v[64:67], v[28:31]
  ds_read_b64_tr_b16 v[140:141], v46 offset:4096
  ds_read_b64_tr_b16 v[142:143], v46 offset:5120
  s_waitcnt vmcnt(12)
  s_waitcnt lgkmcnt(12)
  v_mfma_f32_16x16x32_bf16 v[0:3], v[116:119], v[68:71], v[0:3]
  buffer_load_dwordx4 v[60:63], v33, s[8:11], s32 offen offset:0
  v_mfma_f32_16x16x32_bf16 v[16:19], v[116:119], v[72:75], v[16:19]
  ds_read_b64_tr_b16 v[144:145], v47 offset:4096
  ds_read_b64_tr_b16 v[146:147], v47 offset:5120
  s_waitcnt lgkmcnt(12)
  v_mfma_f32_16x16x32_bf16 v[4:7], v[120:123], v[68:71], v[4:7]
  v_mfma_f32_16x16x32_bf16 v[20:23], v[120:123], v[72:75], v[20:23]
  s_barrier
  v_add_u32 v40, s35, v34
  v_xor_b32 v41, 32, v40
  v_xor_b32 v42, 64, v40
  v_xor_b32 v43, 96, v40
  s_add_u32 s35, s35, 8192
  s_cmp_eq_u32 s35, 49152
  s_cselect_b32 s35, 0, s35
  ds_read_b64_tr_b16 v[116:117], v40 offset:0
  ds_read_b64_tr_b16 v[118:119], v40 offset:1024
  s_waitcnt lgkmcnt(12)
  v_mfma_f32_16x16x32_bf16 v[8:11], v[124:127], v[68:71], v[8:11]
  buffer_load_dwordx4 v[64:67], v33, s[8:11], s32 offen offset:1024
  s_add_u32 s32, s32, 131072
  v_mfma_f32_16x16x32_bf16 v[24:27], v[124:127], v[72:75], v[24:27]
  ds_read_b64_tr_b16 v[120:121], v41 offset:0
  ds_read_b64_tr_b16 v[122:123], v41 offset:1024
  s_waitcnt lgkmcnt(12)
  v_mfma_f32_16x16x32_bf16 v[12:15], v[128:131], v[68:71], v[12:15]
  v_mfma_f32_16x16x32_bf16 v[28:31], v[128:131], v[72:75], v[28:31]
  ds_read_b64_tr_b16 v[124:125], v42 offset:0
  ds_read_b64_tr_b16 v[126:127], v42 offset:1024
  s_waitcnt vmcnt(12)
  s_waitcnt lgkmcnt(12)
  v_mfma_f32_16x16x32_bf16 v[0:3], v[132:135], v[76:79], v[0:3]
  buffer_load_dwordx4 v[68:71], v33, s[8:11], s32 offen offset:0
  v_mfma_f32_16x16x32_bf16 v[16:19], v[132:135], v[80:83], v[16:19]
  ds_read_b64_tr_b16 v[128:129], v43 offset:0
  ds_read_b64_tr_b16 v[130:131], v43 offset:1024
  s_waitcnt lgkmcnt(12)
  v_mfma_f32_16x16x32_bf16 v[4:7], v[136:139], v[76:79], v[4:7]
  v_mfma_f32_16x16x32_bf16 v[20:23], v[136:139], v[80:83], v[20:23]
  ds_read_b64_tr_b16 v[132:133], v40 offset:4096
  ds_read_b64_tr_b16 v[134:135], v40 offset:5120
  s_waitcnt lgkmcnt(12)
  v_mfma_f32_16x16x32_bf16 v[8:11], v[140:143], v[76:79], v[8:11]
  buffer_load_dwordx4 v[72:75], v33, s[8:11], s32 offen offset:1024
  s_add_u32 s32, s32, 131072
  v_mfma_f32_16x16x32_bf16 v[24:27], v[140:143], v[80:83], v[24:27]
  ds_read_b64_tr_b16 v[136:137], v41 offset:4096
  ds_read_b64_tr_b16 v[138:139], v41 offset:5120
  s_waitcnt lgkmcnt(12)
  v_mfma_f32_16x16x32_bf16 v[12:15], v[144:147], v[76:79], v[12:15]
  v_mfma_f32_16x16x32_bf16 v[28:31], v[144:147], v[80:83], v[28:31]
  ds_read_b64_tr_b16 v[140:141], v42 offset:4096
  ds_read_b64_tr_b16 v[142:143], v42 offset:5120
  s_waitcnt vmcnt(12)
  s_waitcnt lgkmcnt(12)
  v_mfma_f32_16x16x32_bf16 v[0:3], v[116:119], v[84:87], v[0:3]
  buffer_load_dwordx4 v[76:79], v33, s[8:11], s32 offen offset:0
  v_mfma_f32_16x16x32_bf16 v[16:19], v[116:119], v[88:91], v[16:19]
  ds_read_b64_tr_b16 v[144:145], v43 offset:4096
  ds_read_b64_tr_b16 v[146:147], v43 offset:5120
  s_waitcnt lgkmcnt(12)
  v_mfma_f32_16x16x32_bf16 v[4:7], v[120:123], v[84:87], v[4:7]
  v_mfma_f32_16x16x32_bf16 v[20:23], v[120:123], v[88:91], v[20:23]
  s_barrier
  v_add_u32 v44, s35, v34
  v_xor_b32 v45, 32, v44
  v_xor_b32 v46, 64, v44
  v_xor_b32 v47, 96, v44
  s_add_u32 s35, s35, 8192
  s_cmp_eq_u32 s35, 49152
  s_cselect_b32 s35, 0, s35
  ds_read_b64_tr_b16 v[116:117], v44 offset:0
  ds_read_b64_tr_b16 v[118:119], v44 offset:1024
  s_waitcnt lgkmcnt(12)
  v_mfma_f32_16x16x32_bf16 v[8:11], v[124:127], v[84:87], v[8:11]
  buffer_load_dwordx4 v[80:83], v33, s[8:11], s32 offen offset:1024
  s_add_u32 s32, s32, 131072
  v_mfma_f32_16x16x32_bf16 v[24:27], v[124:127], v[88:91], v[24:27]
  ds_read_b64_tr_b16 v[120:121], v45 offset:0
  ds_read_b64_tr_b16 v[122:123], v45 offset:1024
  s_waitcnt lgkmcnt(12)
  v_mfma_f32_16x16x32_bf16 v[12:15], v[128:131], v[84:87], v[12:15]
  v_mfma_f32_16x16x32_bf16 v[28:31], v[128:131], v[88:91], v[28:31]
  ds_read_b64_tr_b16 v[124:125], v46 offset:0
  ds_read_b64_tr_b16 v[126:127], v46 offset:1024
  s_waitcnt vmcnt(12)
  s_waitcnt lgkmcnt(12)
  v_mfma_f32_16x16x32_bf16 v[0:3], v[132:135], v[92:95], v[0:3]
  buffer_load_dwordx4 v[84:87], v33, s[8:11], s32 offen offset:0
  v_mfma_f32_16x16x32_bf16 v[16:19], v[132:135], v[96:99], v[16:19]
  ds_read_b64_tr_b16 v[128:129], v47 offset:0
  ds_read_b64_tr_b16 v[130:131], v47 offset:1024
  s_waitcnt lgkmcnt(12)
  v_mfma_f32_16x16x32_bf16 v[4:7], v[136:139], v[92:95], v[4:7]
  v_mfma_f32_16x16x32_bf16 v[20:23], v[136:139], v[96:99], v[20:23]
  ds_read_b64_tr_b16 v[132:133], v44 offset:4096
  ds_read_b64_tr_b16 v[134:135], v44 offset:5120
  s_waitcnt lgkmcnt(12)
  v_mfma_f32_16x16x32_bf16 v[8:11], v[140:143], v[92:95], v[8:11]
  buffer_load_dwordx4 v[88:91], v33, s[8:11], s32 offen offset:1024
  s_add_u32 s32, s32, 131072
  v_mfma_f32_16x16x32_bf16 v[24:27], v[140:143], v[96:99], v[24:27]
  ds_read_b64_tr_b16 v[136:137], v45 offset:4096
  ds_read_b64_tr_b16 v[138:139], v45 offset:5120
  s_waitcnt lgkmcnt(12)
  v_mfma_f32_16x16x32_bf16 v[12:15], v[144:147], v[92:95], v[12:15]
  v_mfma_f32_16x16x32_bf16 v[28:31], v[144:147], v[96:99], v[28:31]
  ds_read_b64_tr_b16 v[140:141], v46 offset:4096
  ds_read_b64_tr_b16 v[142:143], v46 offset:5120
  s_waitcnt vmcnt(12)
  s_waitcnt lgkmcnt(12)
  v_mfma_f32_16x16x32_bf16 v[0:3], v[116:119], v[100:103], v[0:3]
  buffer_load_dwordx4 v[92:95], v33, s[8:11], s32 offen offset:0
  v_mfma_f32_16x16x32_bf16 v[16:19], v[116:119], v[104:107], v[16:19]
  ds_read_b64_tr_b16 v[144:145], v47 offset:4096
  ds_read_b64_tr_b16 v[146:147], v47 offset:5120
  s_waitcnt lgkmcnt(12)
  v_mfma_f32_16x16x32_bf16 v[4:7], v[120:123], v[100:103], v[4:7]
  v_mfma_f32_16x16x32_bf16 v[20:23], v[120:123], v[104:107], v[20:23]
  s_barrier
  v_add_u32 v40, s35, v34
  v_xor_b32 v41, 32, v40
  v_xor_b32 v42, 64, v40
  v_xor_b32 v43, 96, v40
  s_add_u32 s35, s35, 8192
  s_cmp_eq_u32 s35, 49152
  s_cselect_b32 s35, 0, s35
  ds_read_b64_tr_b16 v[116:117], v40 offset:0
  ds_read_b64_tr_b16 v[118:119], v40 offset:1024
  s_waitcnt lgkmcnt(12)
  v_mfma_f32_16x16x32_bf16 v[8:11], v[124:127], v[100:103], v[8:11]
  buffer_load_dwordx4 v[96:99], v33, s[8:11], s32 offen offset:1024
  s_add_u32 s32, s32, 131072
  v_mfma_f32_16x16x32_bf16 v[24:27], v[124:127], v[104:107], v[24:27]
  ds_read_b64_tr_b16 v[120:121], v41 offset:0
  ds_read_b64_tr_b16 v[122:123], v41 offset:1024
  s_waitcnt lgkmcnt(12)
  v_mfma_f32_16x16x32_bf16 v[12:15], v[128:131], v[100:103], v[12:15]
  v_mfma_f32_16x16x32_bf16 v[28:31], v[128:131], v[104:107], v[28:31]
  ds_read_b64_tr_b16 v[124:125], v42 offset:0
  ds_read_b64_tr_b16 v[126:127], v42 offset:1024
  s_waitcnt vmcnt(12)
  s_waitcnt lgkmcnt(12)
  v_mfma_f32_16x16x32_bf16 v[0:3], v[132:135], v[108:111], v[0:3]
  buffer_load_dwordx4 v[100:103], v33, s[8:11], s32 offen offset:0
  v_mfma_f32_16x16x32_bf16 v[16:19], v[132:135], v[112:115], v[16:19]
  ds_read_b64_tr_b16 v[128:129], v43 offset:0
  ds_read_b64_tr_b16 v[130:131], v43 offset:1024
  s_waitcnt lgkmcnt(12)
  v_mfma_f32_16x16x32_bf16 v[4:7], v[136:139], v[108:111], v[4:7]
  v_mfma_f32_16x16x32_bf16 v[20:23], v[136:139], v[112:115], v[20:23]
  ds_read_b64_tr_b16 v[132:133], v40 offset:4096
  ds_read_b64_tr_b16 v[134:135], v40 offset:5120
  s_waitcnt lgkmcnt(12)
  v_mfma_f32_16x16x32_bf16 v[8:11], v[140:143], v[108:111], v[8:11]
  buffer_load_dwordx4 v[104:107], v33, s[8:11], s32 offen offset:1024
  s_add_u32 s32, s32, 131072
  v_mfma_f32_16x16x32_bf16 v[24:27], v[140:143], v[112:115], v[24:27]
  ds_read_b64_tr_b16 v[136:137], v41 offset:4096
  ds_read_b64_tr_b16 v[138:139], v41 offset:5120
  s_waitcnt lgkmcnt(12)
  v_mfma_f32_16x16x32_bf16 v[12:15], v[144:147], v[108:111], v[12:15]
  v_mfma_f32_16x16x32_bf16 v[28:31], v[144:147], v[112:115], v[28:31]
  s_sub_u32 s34, s34, 1
  s_cmp_lg_u32 s34, 0
  s_cbranch_scc1 L_gemm2_kernel_loop0
L_gemm2_kernel_join:
  s_waitcnt vmcnt(0) lgkmcnt(0)
  s_nop 7
  s_nop 7
  s_add_u32 s12, s82, 16777216
  s_addc_u32 s13, s83, 0
  s_mov_b32 s14, 4194304
  s_mov_b32 s15, 0x20000
  v_and_b32 v52, 15, v32
  v_lshrrev_b32 v53, 5, v32
  v_and_b32 v54, 7, v32
  v_xor_b32 v53, v53, v54
  v_lshlrev_b32 v52, 7, v52
  v_lshl_add_u32 v52, v53, 4, v52
  v_bfe_u32 v53, v32, 4, 1
  v_lshl_add_u32 v52, v53, 3, v52
  s_lshl_b32 s21, s20, 12
  s_add_u32 s21, s21, 49152
  v_add_u32 v52, s21, v52
  v_xor_b32 v53, 32, v52
  v_xor_b32 v54, 64, v52
  v_xor_b32 v55, 96, v52
  ds_read_b64 v[148:149], v52 offset:0
  ds_read_b64 v[150:151], v53 offset:0
  ds_read_b64 v[156:157], v52 offset:2048
  ds_read_b64 v[158:159], v53 offset:2048
  ds_read_b64 v[152:153], v54 offset:0
  ds_read_b64 v[154:155], v55 offset:0
  ds_read_b64 v[160:161], v54 offset:2048
  ds_read_b64 v[162:163], v55 offset:2048
  s_waitcnt lgkmcnt(0)
  s_mul_i32 s21, s17, 256
  s_add_u32 s21, s21, s18
  s_lshl_b32 s21, s21, 10
  s_waitcnt vmcnt(0)
  v_lshlrev_b32 v53, 16, v148
  v_and_b32 v54, 0xffff0000, v148
  v_add_f32 v0, v0, v53
  v_add_f32 v1, v1, v54
  v_lshlrev_b32 v53, 16, v149
  v_and_b32 v54, 0xffff0000, v149
  v_add_f32 v2, v2, v53
  v_add_f32 v3, v3, v54
  v_lshlrev_b32 v53, 16, v150
  v_and_b32 v54, 0xffff0000, v150
  v_add_f32 v4, v4, v53
  v_add_f32 v5, v5, v54
  v_lshlrev_b32 v53, 16, v151
  v_and_b32 v54, 0xffff0000, v151
  v_add_f32 v6, v6, v53
  v_add_f32 v7, v7, v54
  v_cvt_pk_bf16_f32 v0, v0, v1
  v_cvt_pk_bf16_f32 v1, v2, v3
  v_cvt_pk_bf16_f32 v2, v4, v5
  v_cvt_pk_bf16_f32 v3, v6, v7
  buffer_store_dwordx4 v[0:3], v33, s[12:15], s21 offen offset:0 sc0 sc1
  v_lshlrev_b32 v53, 16, v156
  v_and_b32 v54, 0xffff0000, v156
  v_add_f32 v16, v16, v53
  v_add_f32 v17, v17, v54
  v_lshlrev_b32 v53, 16, v157
  v_and_b32 v54, 0xffff0000, v157
  v_add_f32 v18, v18, v53
  v_add_f32 v19, v19, v54
  v_lshlrev_b32 v53, 16, v158
  v_and_b32 v54, 0xffff0000, v158
  v_add_f32 v20, v20, v53
  v_add_f32 v21, v21, v54
  v_lshlrev_b32 v53, 16, v159
  v_and_b32 v54, 0xffff0000, v159
  v_add_f32 v22, v22, v53
  v_add_f32 v23, v23, v54
  v_cvt_pk_bf16_f32 v16, v16, v17
  v_cvt_pk_bf16_f32 v17, v18, v19
  v_cvt_pk_bf16_f32 v18, v20, v21
  v_cvt_pk_bf16_f32 v19, v22, v23
  buffer_store_dwordx4 v[16:19], v33, s[12:15], s21 offen offset:1024 sc0 sc1
  s_add_u32 s21, s21, 131072
  v_lshlrev_b32 v53, 16, v152
  v_and_b32 v54, 0xffff0000, v152
  v_add_f32 v8, v8, v53
  v_add_f32 v9, v9, v54
  v_lshlrev_b32 v53, 16, v153
  v_and_b32 v54, 0xffff0000, v153
  v_add_f32 v10, v10, v53
  v_add_f32 v11, v11, v54
  v_lshlrev_b32 v53, 16, v154
  v_and_b32 v54, 0xffff0000, v154
  v_add_f32 v12, v12, v53
  v_add_f32 v13, v13, v54
  v_lshlrev_b32 v53, 16, v155
  v_and_b32 v54, 0xffff0000, v155
  v_add_f32 v14, v14, v53
  v_add_f32 v15, v15, v54
  v_cvt_pk_bf16_f32 v8, v8, v9
  v_cvt_pk_bf16_f32 v9, v10, v11
  v_cvt_pk_bf16_f32 v10, v12, v13
  v_cvt_pk_bf16_f32 v11, v14, v15
  buffer_store_dwordx4 v[8:11], v33, s[12:15], s21 offen offset:0 sc0 sc1
  v_lshlrev_b32 v53, 16, v160
  v_and_b32 v54, 0xffff0000, v160
  v_add_f32 v24, v24, v53
  v_add_f32 v25, v25, v54
  v_lshlrev_b32 v53, 16, v161
  v_and_b32 v54, 0xffff0000, v161
  v_add_f32 v26, v26, v53
  v_add_f32 v27, v27, v54
  v_lshlrev_b32 v53, 16, v162
  v_and_b32 v54, 0xffff0000, v162
  v_add_f32 v28, v28, v53
  v_add_f32 v29, v29, v54
  v_lshlrev_b32 v53, 16, v163
  v_and_b32 v54, 0xffff0000, v163
  v_add_f32 v30, v30, v53
  v_add_f32 v31, v31, v54
  v_cvt_pk_bf16_f32 v24, v24, v25
  v_cvt_pk_bf16_f32 v25, v26, v27
  v_cvt_pk_bf16_f32 v26, v28, v29
  v_cvt_pk_bf16_f32 v27, v30, v31
  buffer_store_dwordx4 v[24:27], v33, s[12:15], s21 offen offset:1024 sc0 sc1
  s_add_u32 s21, s21, 131072
  v_mov_b32 v76, 0x3f803f80
  v_mov_b32 v77, 0x3f803f80
  v_mov_b32 v78, 0x3f803f80
  v_mov_b32 v79, 0x3f803f80
  s_nop 1
  v_mfma_f32_16x16x32_bf16 v[80:83], v[76:79], v[0:3], 0
  v_mfma_f32_16x16x32_bf16 v[84:87], v[0:3], v[0:3], 0
  v_mfma_f32_16x16x32_bf16 v[88:91], v[76:79], v[16:19], 0
  v_mfma_f32_16x16x32_bf16 v[92:95], v[16:19], v[16:19], 0
  v_mfma_f32_16x16x32_bf16 v[80:83], v[76:79], v[8:11], v[80:83]
  v_mfma_f32_16x16x32_bf16 v[84:87], v[8:11], v[8:11], v[84:87]
  v_mfma_f32_16x16x32_bf16 v[88:91], v[76:79], v[24:27], v[88:91]
  v_mfma_f32_16x16x32_bf16 v[92:95], v[24:27], v[24:27], v[92:95]
  s_add_u32 s4, s82, 20971520
  s_addc_u32 s5, s83, 0
  s_mov_b32 s6, 1048576
  s_mov_b32 s7, 0x20000
  s_mov_b32 s22, 572662306
  s_mov_b32 s23, 572662306
  s_mov_b32 s24, 1145324612
  s_mov_b32 s25, 1145324612
  s_mov_b32 s26, 2290649224
  s_mov_b32 s27, 2290649224
  v_and_b32 v52, 15, v32
  v_lshlrev_b32 v52, 3, v52
  s_lshl_b32 s21, s18, 7
  s_lshl_b32 s28, s17, 14
  s_add_u32 s21, s21, s28
  s_nop 7
  s_nop 7
  v_cndmask_b32 v81, v84, v85, s[22:23]
  v_cndmask_b32 v81, v81, v86, s[24:25]
  v_cndmask_b32 v81, v81, v87, s[26:27]
  v_cndmask_b32 v89, v92, v93, s[22:23]
  v_cndmask_b32 v89, v89, v94, s[24:25]
  v_cndmask_b32 v89, v89, v95, s[26:27]
  s_mov_b32 exec_lo, 0x00f0000f
  s_mov_b32 exec_hi, 0xf0000f00
  buffer_store_dwordx2 v[80:81], v52, s[4:7], s21 offen offset:0 sc0 sc1
  buffer_store_dwordx2 v[88:89], v52, s[4:7], s21 offen offset:128 sc0 sc1
L_gemm2_kernel_end:
  s_endpgm
.globl gemm3_kernel
.p2align 8
.type gemm3_kernel,@function
gemm3_kernel:
  s_cmp_ge_u32 s2, 256
  s_cbranch_scc1 L_gemm3_kernel_end
  s_load_dwordx16 s[64:79], s[0:1], 0
  s_load_dwordx4 s[80:83], s[0:1], 64
  v_lshrrev_b32 v115, 6, v0
  v_and_b32 v112, 63, v0
  s_nop 0
  v_readfirstlane_b32 s20, v115
  s_and_b32 s21, s2, 7
  s_lshr_b32 s22, s2, 3
  s_and_b32 s23, s21, 3
  s_lshr_b32 s24, s21, 2
  s_and_b32 s26, s22, 3
  s_lshr_b32 s25, s22, 2
  s_mul_i32 s23, s23, 8
  s_add_u32 s17, s23, s25
  s_mul_i32 s24, s24, 4
  s_add_u32 s16, s24, s26
  v_lshlrev_b32 v113, 4, v112
  v_lshrrev_b32 v115, 5, v112
  v_mul_u32_u24 v114, 4096, v115
  v_bfe_u32 v116, v112, 2, 3
  v_lshl_add_u32 v114, v116, 7, v114
  v_lshrrev_b32 v116, 1, v116
  v_lshl_add_u32 v114, v116, 5, v114
  v_and_b32 v115, 3, v112
  v_lshl_add_u32 v114, v115, 3, v114
  s_mov_b32 s19, s20
  s_mul_i32 s27, s19, 4
  v_lshrrev_b32 v117, 4, v112
  v_bfe_u32 v116, v112, 1, 2
  v_xor_b32 v116, v116, v117
  v_lshrrev_b32 v115, 5, v112
  v_mul_u32_u24 v115, 4, v115
  v_bfe_u32 v117, v112, 3, 2
  v_add_u32 v115, v115, v117
  v_mul_u32_u24 v115, 7168, v115
  v_lshl_add_u32 v115, v116, 5, v115
  v_and_b32 v117, 1, v112
  v_lshl_add_u32 v115, v117, 4, v115
  s_add_u32 s28, s27, 0
  s_cmp_ge_u32 s28, 16
  s_cselect_b32 s29, 16, 0
  s_sub_u32 s28, s28, s29
  s_mul_i32 s29, s28, 32768
  s_lshr_b32 s29, s29, 16
  s_mul_i32 s30, s29, 2
  s_sub_u32 s28, s28, s30
  s_lshr_b32 s30, s29, 2
  s_mul_i32 s30, s30, 229376
  s_bfe_u32 s31, s29, 0x10001
  s_mul_i32 s31, s31, 57344
  s_add_u32 s30, s30, s31
  s_and_b32 s31, s29, 1
  s_mul_i32 s31, s31, 114688
  s_add_u32 s30, s30, s31
  s_mul_i32 s31, s28, 128
  s_add_u32 s30, s30, s31
  v_add_u32 v128, s30, v115
  s_lshl_b32 s28, s28, 2
  v_add_u32 v117, s28, v116
  v_cmp_le_u32 vcc, 7, v117
  v_mov_b32 v117, 0x7ff00000
  v_cndmask_b32 v128, v128, v117, vcc
  s_add_u32 s28, s27, 1
  s_cmp_ge_u32 s28, 16
  s_cselect_b32 s29, 16, 0
  s_sub_u32 s28, s28, s29
  s_mul_i32 s29, s28, 32768
  s_lshr_b32 s29, s29, 16
  s_mul_i32 s30, s29, 2
  s_sub_u32 s28, s28, s30
  s_lshr_b32 s30, s29, 2
  s_mul_i32 s30, s30, 229376
  s_bfe_u32 s31, s29, 0x10001
  s_mul_i32 s31, s31, 57344
  s_add_u32 s30, s30, s31
  s_and_b32 s31, s29, 1
  s_mul_i32 s31, s31, 114688
  s_add_u32 s30, s30, s31
  s_mul_i32 s31, s28, 128
  s_add_u32 s30, s30, s31
  v_add_u32 v129, s30, v115
  s_lshl_b32 s28, s28, 2
  v_add_u32 v117, s28, v116
  v_cmp_le_u32 vcc, 7, v117
  v_mov_b32 v117, 0x7ff00000
  v_cndmask_b32 v129, v129, v117, vcc
  s_add_u32 s28, s27, 2
  s_cmp_ge_u32 s28, 16
  s_cselect_b32 s29, 16, 0
  s_sub_u32 s28, s28, s29
  s_mul_i32 s29, s28, 32768
  s_lshr_b32 s29, s29, 16
  s_mul_i32 s30, s29, 2
  s_sub_u32 s28, s28, s30
  s_lshr_b32 s30, s29, 2
  s_mul_i32 s30, s30, 229376
  s_bfe_u32 s31, s29, 0x10001
  s_mul_i32 s31, s31, 57344
  s_add_u32 s30, s30, s31
  s_and_b32 s31, s29, 1
  s_mul_i32 s31, s31, 114688
  s_add_u32 s30, s30, s31
  s_mul_i32 s31, s28, 128
  s_add_u32 s30, s30, s31
  v_add_u32 v130, s30, v115
  s_lshl_b32 s28, s28, 2
  v_add_u32 v117, s28, v116
  v_cmp_le_u32 vcc, 7, v117
  v_mov_b32 v117, 0x7ff00000
  v_cndmask_b32 v130, v130, v117, vcc
  s_add_u32 s28, s27, 3
  s_cmp_ge_u32 s28, 16
  s_cselect_b32 s29, 16, 0
  s_sub_u32 s28, s28, s29
  s_mul_i32 s29, s28, 32768
  s_lshr_b32 s29, s29, 16
  s_mul_i32 s30, s29, 2
  s_sub_u32 s28, s28, s30
  s_lshr_b32 s30, s29, 2
  s_mul_i32 s30, s30, 229376
  s_bfe_u32 s31, s29, 0x10001
  s_mul_i32 s31, s31, 57344
  s_add_u32 s30, s30, s31
  s_and_b32 s31, s29, 1
  s_mul_i32 s31, s31, 114688
  s_add_u32 s30, s30, s31
  s_mul_i32 s31, s28, 128
  s_add_u32 s30, s30, s31
  v_add_u32 v131, s30, v115
  s_lshl_b32 s28, s28, 2
  v_add_u32 v117, s28, v116
  v_cmp_le_u32 vcc, 7, v117
  v_mov_b32 v117, 0x7ff00000
  v_cndmask_b32 v131, v131, v117, vcc
  s_waitcnt lgkmcnt(0)
  s_add_u32 s8, s82, 16777216
  s_addc_u32 s9, s83, 0
  s_mov_b32 s10, 4194304
  s_mov_b32 s11, 0x20000
  s_add_u32 s28, s27, 0
  s_cmp_ge_u32 s28, 16
  s_cselect_b32 s40, s74, s72
  s_cselect_b32 s41, s75, s73
  s_cmp_ge_u32 s28, 32
  s_cselect_b32 s42, 0, 7340032
  s_mov_b32 s43, 0x20000
  s_mul_i32 s32, s16, 16
  s_mul_i32 s28, s20, 2
  s_add_u32 s18, s32, s28
  s_lshl_b32 s32, s18, 10
  s_mul_i32 s33, s17, 224
  s_lshl_b32 s39, s27, 10
  s_mov_b32 s37, 0
  s_mov_b32 s35, 0
  s_mov_b32 s38, 0x7ff00000
  s_add_u32 s4, s82, 20971520
  s_addc_u32 s5, s83, 0
  s_mov_b32 s6, 2097152
  s_mov_b32 s7, 0x20000
  s_lshl_b32 s28, s2, 2
  s_add_u32 s28, s28, s20
  s_cmp_ge_u32 s20, 4
  s_cselect_b32 s28, 0x10000, s28
  s_mov_b32 s44, s76
  s_mov_b32 s45, s77
  s_mov_b32 s46, 7340032
  s_mov_b32 s47, 0x20000
  s_add_u32 s48, s82, 24117248
  s_addc_u32 s49, s83, 0
  s_mov_b32 s50, 917504
  s_mov_b32 s51, 0x20000
  s_cmp_ge_u32 s28, 896
  s_cselect_b32 s46, 0, s46
  s_cselect_b32 s50, 0, s50
  s_lshl_b32 s53, s28, 10
  s_cmp_ge_u32 s28, 448
  s_cselect_b32 s30, 448, 0
  s_cselect_b32 s29, 1408, 0
  s_sub_u32 s28, s28, s30
  s_max_u32 s29, s29, 384
  s_lshl_b32 s52, s28, 14
  s_add_u32 s52, s52, s29
  v_lshrrev_b32 v115, 3, v112
  v_lshlrev_b32 v115, 11, v115
  v_and_b32 v212, 7, v112
  v_lshl_add_u32 v212, v212, 4, v115
  s_bfe_u32 s28, s2, 0x20003
  s_sub_u32 s54, 8, s28
  s_sub_u32 s55, 5, s28
  v_lshrrev_b32 v115, 5, v112
  v_mul_u32_u24 v115, 14336, v115
  v_and_b32 v116, 31, v112
  v_lshl_add_u32 v115, v116, 4, v115
  s_mul_i32 s3, s20, 57344
  s_mul_i32 s28, s17, 448
  s_add_u32 s3, s3, s28
  s_add_u32 s3, s3, 1048576
  s_lshl_b32 s28, s20, 11
  s_add_u32 m0, s28, 131072
  s_nop 0
  buffer_load_dwordx4 v115, s[4:7], s3 offen lds
  s_add_u32 s3, s3, 28672
  s_add_u32 m0, s28, 132096
  s_nop 0
  buffer_load_dwordx4 v115, s[4:7], s3 offen lds
  s_cmp_lt_u32 s20, 4
  s_cselect_b32 s58, 6, 0
  s_mov_b32 s60, s76
  s_mov_b32 s61, s77
  s_mov_b32 s62, 7340032
  s_mov_b32 s63, 0x20000
  s_lshl_b32 s28, s2, 3
  s_add_u32 s28, s28, s20
  s_lshl_b32 s59, s28, 12
  v_lshlrev_b32 v118, 7, v112
  buffer_load_dwordx4 v[140:143], v113, s[8:11], s38 offen offset:0
  buffer_load_dwordx4 v[144:147], v113, s[8:11], s38 offen offset:1024
  buffer_load_dwordx4 v[148:151], v113, s[8:11], s38 offen offset:0
  buffer_load_dwordx4 v[152:155], v113, s[8:11], s38 offen offset:1024
  s_add_u32 s36, s37, s39
  s_add_u32 s37, s37, 32768
  s_cmp_eq_u32 s37, 131072
  s_cselect_b32 s37, 0, s37
  s_add_u32 m0, s36, 0
  s_nop 0
  buffer_load_dwordx4 v128, s[40:43], s33 offen lds
  s_add_u32 m0, s36, 1024
  s_nop 0
  buffer_load_dwordx4 v129, s[40:43], s33 offen lds
  s_add_u32 m0, s36, 2048
  s_nop 0
  buffer_load_dwordx4 v130, s[40:43], s33 offen lds
  s_add_u32 m0, s36, 3072
  s_nop 0
  buffer_load_dwordx4 v131, s[40:43], s33 offen lds
  s_add_u32 s33, s33, 458752
  buffer_load_dwordx4 v[156:159], v113, s[8:11], s38 offen offset:0
  buffer_load_dwordx4 v[160:163], v113, s[8:11], s38 offen offset:1024
  buffer_load_dwordx4 v[132:135], v113, s[8:11], s32 offen offset:0
  buffer_load_dwordx4 v[136:139], v113, s[8:11], s32 offen offset:1024
  s_add_u32 s32, s32, 131072
  s_add_u32 s36, s37, s39
  s_add_u32 s37, s37, 32768
  s_cmp_eq_u32 s37, 131072
  s_cselect_b32 s37, 0, s37
  s_add_u32 m0, s36, 0
  s_nop 0
  buffer_load_dwordx4 v128, s[40:43], s33 offen lds
  s_add_u32 m0, s36, 1024
  s_nop 0
  buffer_load_dwordx4 v129, s[40:43], s33 offen lds
  s_add_u32 m0, s36, 2048
  s_nop 0
  buffer_load_dwordx4 v130, s[40:43], s33 offen lds
  s_add_u32 m0, s36, 3072
  s_nop 0
  buffer_load_dwordx4 v131, s[40:43], s33 offen lds
  s_add_u32 s33, s33, 458752
  buffer_load_dwordx4 v[140:143], v113, s[8:11], s32 offen offset:0
  buffer_load_dwordx4 v[144:147], v113, s[8:11], s32 offen offset:1024
  s_add_u32 s32, s32, 131072
  buffer_load_dwordx4 v[148:151], v113, s[8:11], s32 offen offset:0
  buffer_load_dwordx4 v[152:155], v113, s[8:11], s32 offen offset:1024
  s_add_u32 s32, s32, 131072
  v_mov_b32 v0, 0
  v_mov_b32 v1, 0
  v_mov_b32 v2, 0
  v_mov_b32 v3, 0
  v_mov_b32 v4, 0
  v_mov_b32 v5, 0
  v_mov_b32 v6, 0
  v_mov_b32 v7, 0
  v_mov_b32 v8, 0
  v_mov_b32 v9, 0
  v_mov_b32 v10, 0
  v_mov_b32 v11, 0
  v_mov_b32 v12, 0
  v_mov_b32 v13, 0
  v_mov_b32 v14, 0
  v_mov_b32 v15, 0
  v_mov_b32 v16, 0
  v_mov_b32 v17, 0
  v_mov_b32 v18, 0
  v_mov_b32 v19, 0
  v_mov_b32 v20, 0
  v_mov_b32 v21, 0
  v_mov_b32 v22, 0
  v_mov_b32 v23, 0
  v_mov_b32 v24, 0
  v_mov_b32 v25, 0
  v_mov_b32 v26, 0
  v_mov_b32 v27, 0
  v_mov_b32 v28, 0
  v_mov_b32 v29, 0
  v_mov_b32 v30, 0
  v_mov_b32 v31, 0
  v_mov_b32 v32, 0
  v_mov_b32 v33, 0
  v_mov_b32 v34, 0
  v_mov_b32 v35, 0
  v_mov_b32 v36, 0
  v_mov_b32 v37, 0
  v_mov_b32 v38, 0
  v_mov_b32 v39, 0
  v_mov_b32 v40, 0
  v_mov_b32 v41, 0
  v_mov_b32 v42, 0
  v_mov_b32 v43, 0
  v_mov_b32 v44, 0
  v_mov_b32 v45, 0
  v_mov_b32 v46, 0
  v_mov_b32 v47, 0
  v_mov_b32 v48, 0
  v_mov_b32 v49, 0
  v_mov_b32 v50, 0
  v_mov_b32 v51, 0
  v_mov_b32 v52, 0
  v_mov_b32 v53, 0
  v_mov_b32 v54, 0
  v_mov_b32 v55, 0
  v_mov_b32 v56, 0
  v_mov_b32 v57, 0
  v_mov_b32 v58, 0
  v_mov_b32 v59, 0
  v_mov_b32 v60, 0
  v_mov_b32 v61, 0
  v_mov_b32 v62, 0
  v_mov_b32 v63, 0
  v_mov_b32 v64, 0
  v_mov_b32 v65, 0
  v_mov_b32 v66, 0
  v_mov_b32 v67, 0
  v_mov_b32 v68, 0
  v_mov_b32 v69, 0
  v_mov_b32 v70, 0
  v_mov_b32 v71, 0
  v_mov_b32 v72, 0
  v_mov_b32 v73, 0
  v_mov_b32 v74, 0
  v_mov_b32 v75, 0
  v_mov_b32 v76, 0
  v_mov_b32 v77, 0
  v_mov_b32 v78, 0
  v_mov_b32 v79, 0
  v_mov_b32 v80, 0
  v_mov_b32 v81, 0
  v_mov_b32 v82, 0
  v_mov_b32 v83, 0
  v_mov_b32 v84, 0
  v_mov_b32 v85, 0
  v_mov_b32 v86, 0
  v_mov_b32 v87, 0
  v_mov_b32 v88, 0
  v_mov_b32 v89, 0
  v_mov_b32 v90, 0
  v_mov_b32 v91, 0
  v_mov_b32 v92, 0
  v_mov_b32 v93, 0
  v_mov_b32 v94, 0
  v_mov_b32 v95, 0
  v_mov_b32 v96, 0
  v_mov_b32 v97, 0
  v_mov_b32 v98, 0
  v_mov_b32 v99, 0
  v_mov_b32 v100, 0
  v_mov_b32 v101, 0
  v_mov_b32 v102, 0
  v_mov_b32 v103, 0
  v_mov_b32 v104, 0
  v_mov_b32 v105, 0
  v_mov_b32 v106, 0
  v_mov_b32 v107, 0
  v_mov_b32 v108, 0
  v_mov_b32 v109, 0
  v_mov_b32 v110, 0
  v_mov_b32 v111, 0
  s_waitcnt vmcnt(12)
  s_barrier
  v_add_u32 v120, s35, v114
  v_xor_b32 v121, 32, v120
  v_xor_b32 v122, 64, v120
  v_xor_b32 v123, 96, v120
  s_add_u32 s35, s35, 32768
  s_cmp_eq_u32 s35, 131072
  s_cselect_b32 s35, 0, s35
  s_add_u32 s36, s37, s39
  s_add_u32 s37, s37, 32768
  s_cmp_eq_u32 s37, 131072
  s_cselect_b32 s37, 0, s37
  ds_read_b64_tr_b16 v[164:165], v120 offset:0
  ds_read_b64_tr_b16 v[166:167], v120 offset:2048
  ds_read_b64_tr_b16 v[168:169], v121 offset:0
  ds_read_b64_tr_b16 v[170:171], v121 offset:2048
  ds_read_b64_tr_b16 v[172:173], v122 offset:0
  ds_read_b64_tr_b16 v[174:175], v122 offset:2048
  s_add_u32 m0, s36, 0
  s_nop 0
  buffer_load_dwordx4 v128, s[40:43], s33 offen lds
  ds_read_b64_tr_b16 v[176:177], v123 offset:0
  ds_read_b64_tr_b16 v[178:179], v123 offset:2048
  ds_read_b64_tr_b16 v[180:181], v120 offset:1024
  ds_read_b64_tr_b16 v[182:183], v120 offset:3072
  ds_read_b64_tr_b16 v[184:185], v121 offset:1024
  ds_read_b64_tr_b16 v[186:187], v121 offset:3072
  s_add_u32 m0, s36, 1024
  s_nop 0
  buffer_load_dwordx4 v129, s[40:43], s33 offen lds
  s_mov_b32 s34, 8
L_gemm3_kernel_loop0:
  ds_read_b64_tr_b16 v[188:189], v122 offset:1024
  ds_read_b64_tr_b16 v[190:191], v122 offset:3072
  s_waitcnt vmcnt(10)
  s_waitcnt lgkmcnt(12)
  v_mfma_f32_16x16x32_bf16 v[0:3], v[164:167], v[132:135], v[0:3]
  s_add_u32 m0, s36, 2048
  s_nop 0
  buffer_load_dwordx4 v130, s[40:43], s33 offen lds
  v_mfma_f32_16x16x32_bf16 v[56:59], v[164:167], v[136:139], v[56:59]
  ds_read_b64_tr_b16 v[164:165], v120 offset:16384
  ds_read_b64_tr_b16 v[166:167], v120 offset:18432
  s_waitcnt lgkmcnt(12)
  v_mfma_f32_16x16x32_bf16 v[4:7], v[168:171], v[132:135], v[4:7]
  v_mfma_f32_16x16x32_bf16 v[60:63], v[168:171], v[136:139], v[60:63]
  s_cmp_lg_u32 s34, 1
  s_cbranch_scc1 L_gemm3_kernel_nl
  v_and_b32 v115, 15, v112
  v_lshlrev_b32 v115, 3, v115
  v_lshrrev_b32 v116, 4, v112
  v_lshl_add_u32 v115, v116, 16, v115
  s_lshl_b32 s3, s18, 7
  buffer_load_dwordx2 v[192:193], v115, s[4:7], s3 offen offset:0
  buffer_load_dwordx2 v[200:201], v115, s[4:7], s3 offen offset:128
  s_add_u32 s3, s3, 16384
  buffer_load_dwordx2 v[194:195], v115, s[4:7], s3 offen offset:0
  buffer_load_dwordx2 v[202:203], v115, s[4:7], s3 offen offset:128
  s_add_u32 s3, s3, 16384
  buffer_load_dwordx2 v[196:197], v115, s[4:7], s3 offen offset:0
  buffer_load_dwordx2 v[204:205], v115, s[4:7], s3 offen offset:128
  s_add_u32 s3, s3, 16384
  buffer_load_dwordx2 v[198:199], v115, s[4:7], s3 offen offset:0
  buffer_load_dwordx2 v[206:207], v115, s[4:7], s3 offen offset:128
  s_add_u32 s3, s3, 16384
L_gemm3_kernel_nl:
  ds_read_b64_tr_b16 v[168:169], v121 offset:16384
  ds_read_b64_tr_b16 v[170:171], v121 offset:18432
  s_waitcnt lgkmcnt(12)
  v_mfma_f32_16x16x32_bf16 v[8:11], v[172:175], v[132:135], v[8:11]
  v_mfma_f32_16x16x32_bf16 v[64:67], v[172:175], v[136:139], v[64:67]
  ds_read_b64_tr_b16 v[172:173], v122 offset:16384
  ds_read_b64_tr_b16 v[174:175], v122 offset:18432
  s_waitcnt lgkmcnt(12)
  v_mfma_f32_16x16x32_bf16 v[12:15], v[176:179], v[132:135], v[12:15]
  s_add_u32 m0, s36, 3072
  s_nop 0
  buffer_load_dwordx4 v131, s[40:43], s33 offen lds
  s_add_u32 s33, s33, 458752
  v_mfma_f32_16x16x32_bf16 v[68:71], v[176:179], v[136:139], v[68:71]
  s_cmp_lg_u32 s34, s54
  s_cbranch_scc1 L_gemm3_kernel_hk0
  buffer_load_dwordx4 v[208:211], v212, s[44:47], s52 offen
L_gemm3_kernel_hk0:
  ds_read_b64_tr_b16 v[176:177], v123 offset:16384
  ds_read_b64_tr_b16 v[178:179], v123 offset:18432
  s_waitcnt lgkmcnt(12)
  v_mfma_f32_16x16x32_bf16 v[16:19], v[180:183], v[132:135], v[16:19]
  v_mfma_f32_16x16x32_bf16 v[72:75], v[180:183], v[136:139], v[72:75]
  ds_read_b64_tr_b16 v[180:181], v120 offset:17408
  ds_read_b64_tr_b16 v[182:183], v120 offset:19456
  s_waitcnt lgkmcnt(12)
  v_mfma_f32_16x16x32_bf16 v[20:23], v[184:187], v[132:135], v[20:23]
  v_mfma_f32_16x16x32_bf16 v[76:79], v[184:187], v[136:139], v[76:79]
  s_cmp_lg_u32 s34, s55
  s_cbranch_scc1 L_gemm3_kernel_hk1
  buffer_store_dwordx4 v[208:211], v113, s[48:51], s53 offen sc0 sc1
L_gemm3_kernel_hk1:
  ds_read_b64_tr_b16 v[184:185], v121 offset:17408
  ds_read_b64_tr_b16 v[186:187], v121 offset:19456
  s_waitcnt lgkmcnt(12)
  v_mfma_f32_16x16x32_bf16 v[24:27], v[188:191], v[132:135], v[24:27]
  buffer_load_dwordx4 v[156:159], v113, s[8:11], s32 offen offset:0
  v_mfma_f32_16x16x32_bf16 v[80:83], v[188:191], v[136:139], v[80:83]
  ds_read_b64_tr_b16 v[188:189], v122 offset:17408
  ds_read_b64_tr_b16 v[190:191], v122 offset:19456
  s_waitcnt lgkmcnt(12)
  v_mfma_f32_16x16x32_bf16 v[28:31], v[164:167], v[132:135], v[28:31]
  v_mfma_f32_16x16x32_bf16 v[84:87], v[164:167], v[136:139], v[84:87]
  ds_read_b64_tr_b16 v[164:165], v120 offset:8192
  ds_read_b64_tr_b16 v[166:167], v120 offset:10240
  s_waitcnt lgkmcnt(12)
  v_mfma_f32_16x16x32_bf16 v[32:35], v[168:171], v[132:135], v[32:35]
  v_mfma_f32_16x16x32_bf16 v[88:91], v[168:171], v[136:139], v[88:91]
  ds_read_b64_tr_b16 v[168:169], v121 offset:8192
  ds_read_b64_tr_b16 v[170:171], v121 offset:10240
  s_waitcnt lgkmcnt(12)
  v_mfma_f32_16x16x32_bf16 v[36:39], v[172:175], v[132:135], v[36:39]
  buffer_load_dwordx4 v[160:163], v113, s[8:11], s32 offen offset:1024
  s_add_u32 s32, s32, 131072
  v_mfma_f32_16x16x32_bf16 v[92:95], v[172:175], v[136:139], v[92:95]
  ds_read_b64_tr_b16 v[172:173], v122 offset:8192
  ds_read_b64_tr_b16 v[174:175], v122 offset:10240
  s_waitcnt lgkmcnt(12)
  v_mfma_f32_16x16x32_bf16 v[40:43], v[176:179], v[132:135], v[40:43]
  v_mfma_f32_16x16x32_bf16 v[96:99], v[176:179], v[136:139], v[96:99]
  ds_read_b64_tr_b16 v[176:177], v123 offset:8192
  ds_read_b64_tr_b16 v[178:179], v123 offset:10240
  s_waitcnt lgkmcnt(12)
  v_mfma_f32_16x16x32_bf16 v[44:47], v[180:183], v[132:135], v[44:47]
  v_mfma_f32_16x16x32_bf16 v[100:103], v[180:183], v[136:139], v[100:103]
  ds_read_b64_tr_b16 v[180:181], v120 offset:9216
  ds_read_b64_tr_b16 v[182:183], v120 offset:11264
  s_waitcnt lgkmcnt(12)
  v_mfma_f32_16x16x32_bf16 v[48:51], v[184:187], v[132:135], v[48:51]
  v_mfma_f32_16x16x32_bf16 v[104:107], v[184:187], v[136:139], v[104:107]
  ds_read_b64_tr_b16 v[184:185], v121 offset:9216
  ds_read_b64_tr_b16 v[186:187], v121 offset:11264
  s_waitcnt lgkmcnt(12)
  v_mfma_f32_16x16x32_bf16 v[52:55], v[188:191], v[132:135], v[52:55]
  v_mfma_f32_16x16x32_bf16 v[108:111], v[188:191], v[136:139], v[108:111]
  ds_read_b64_tr_b16 v[188:189], v122 offset:9216
  ds_read_b64_tr_b16 v[190:191], v122 offset:11264
  s_waitcnt vmcnt(8)
  s_waitcnt lgkmcnt(12)
  v_mfma_f32_16x16x32_bf16 v[0:3], v[164:167], v[140:143], v[0:3]
  v_mfma_f32_16x16x32_bf16 v[56:59], v[164:167], v[144:147], v[56:59]
  ds_read_b64_tr_b16 v[164:165], v120 offset:24576
  ds_read_b64_tr_b16 v[166:167], v120 offset:26624
  s_waitcnt lgkmcnt(12)
  v_mfma_f32_16x16x32_bf16 v[4:7], v[168:171], v[140:143], v[4:7]
  buffer_load_dwordx4 v[132:135], v113, s[8:11], s32 offen offset:0
  v_mfma_f32_16x16x32_bf16 v[60:63], v[168:171], v[144:147], v[60:63]
  ds_read_b64_tr_b16 v[168:169], v121 offset:24576
  ds_read_b64_tr_b16 v[170:171], v121 offset:26624
  s_waitcnt lgkmcnt(12)
  v_mfma_f32_16x16x32_bf16 v[8:11], v[172:175], v[140:143], v[8:11]
  v_mfma_f32_16x16x32_bf16 v[64:67], v[172:175], v[144:147], v[64:67]
  ds_read_b64_tr_b16 v[172:173], v122 offset:24576
  ds_read_b64_tr_b16 v[174:175], v122 offset:26624
  s_waitcnt lgkmcnt(12)
  v_mfma_f32_16x16x32_bf16 v[12:15], v[176:179], v[140:143], v[12:15]
  v_mfma_f32_16x16x32_bf16 v[68:71], v[176:179], v[144:147], v[68:71]
  ds_read_b64_tr_b16 v[176:177], v123 offset:24576
  ds_read_b64_tr_b16 v[178:179], v123 offset:26624
  s_waitcnt lgkmcnt(12)
  v_mfma_f32_16x16x32_bf16 v[16:19], v[180:183], v[140:143], v[16:19]
  buffer_load_dwordx4 v[136:139], v113, s[8:11], s32 offen offset:1024
  s_add_u32 s32, s32, 131072
  v_mfma_f32_16x16x32_bf16 v[72:75], v[180:183], v[144:147], v[72:75]
  ds_read_b64_tr_b16 v[180:181], v120 offset:25600
  ds_read_b64_tr_b16 v[182:183], v120 offset:27648
  s_waitcnt lgkmcnt(12)
  v_mfma_f32_16x16x32_bf16 v[20:23], v[184:187], v[140:143], v[20:23]
  v_mfma_f32_16x16x32_bf16 v[76:79], v[184:187], v[144:147], v[76:79]
  ds_read_b64_tr_b16 v[184:185], v121 offset:25600
  ds_read_b64_tr_b16 v[186:187], v121 offset:27648
  s_waitcnt lgkmcnt(12)
  v_mfma_f32_16x16x32_bf16 v[24:27], v[188:191], v[140:143], v[24:27]
  v_mfma_f32_16x16x32_bf16 v[80:83], v[188:191], v[144:147], v[80:83]
  ds_read_b64_tr_b16 v[188:189], v122 offset:25600
  ds_read_b64_tr_b16 v[190:191], v122 offset:27648
  s_waitcnt lgkmcnt(12)
  v_mfma_f32_16x16x32_bf16 v[28:31], v[164:167], v[140:143], v[28:31]
  v_mfma_f32_16x16x32_bf16 v[84:87], v[164:167], v[144:147], v[84:87]
  s_barrier
  v_add_u32 v124, s35, v114
  v_xor_b32 v125, 32, v124
  v_xor_b32 v126, 64, v124
  v_xor_b32 v127, 96, v124
  s_add_u32 s35, s35, 32768
  s_cmp_eq_u32 s35, 131072
  s_cselect_b32 s35, 0, s35
  s_add_u32 s36, s37, s39
  s_add_u32 s37, s37, 32768
  s_cmp_eq_u32 s37, 131072
  s_cselect_b32 s37, 0, s37
  ds_read_b64_tr_b16 v[164:165], v124 offset:0
  ds_read_b64_tr_b16 v[166:167], v124 offset:2048
  s_waitcnt lgkmcnt(12)
  v_mfma_f32_16x16x32_bf16 v[32:35], v[168:171], v[140:143], v[32:35]
  v_mfma_f32_16x16x32_bf16 v[88:91], v[168:171], v[144:147], v[88:91]
  ds_read_b64_tr_b16 v[168:169], v125 offset:0
  ds_read_b64_tr_b16 v[170:171], v125 offset:2048
  s_waitcnt lgkmcnt(12)
  v_mfma_f32_16x16x32_bf16 v[36:39], v[172:175], v[140:143], v[36:39]
  v_mfma_f32_16x16x32_bf16 v[92:95], v[172:175], v[144:147], v[92:95]
  ds_read_b64_tr_b16 v[172:173], v126 offset:0
  ds_read_b64_tr_b16 v[174:175], v126 offset:2048
  s_waitcnt lgkmcnt(12)
  v_mfma_f32_16x16x32_bf16 v[40:43], v[176:179], v[140:143], v[40:43]
  s_add_u32 m0, s36, 0
  s_nop 0
  buffer_load_dwordx4 v128, s[40:43], s33 offen lds
  v_mfma_f32_16x16x32_bf16 v[96:99], v[176:179], v[144:147], v[96:99]
  ds_read_b64_tr_b16 v[176:177], v127 offset:0
  ds_read_b64_tr_b16 v[178:179], v127 offset:2048
  s_waitcnt lgkmcnt(12)
  v_mfma_f32_16x16x32_bf16 v[44:47], v[180:183], v[140:143], v[44:47]
  v_mfma_f32_16x16x32_bf16 v[100:103], v[180:183], v[144:147], v[100:103]
  ds_read_b64_tr_b16 v[180:181], v124 offset:1024
  ds_read_b64_tr_b16 v[182:183], v124 offset:3072
  s_waitcnt lgkmcnt(12)
  v_mfma_f32_16x16x32_bf16 v[48:51], v[184:187], v[140:143], v[48:51]
  v_mfma_f32_16x16x32_bf16 v[104:107], v[184:187], v[144:147], v[104:107]
  ds_read_b64_tr_b16 v[184:185], v125 offset:1024
  ds_read_b64_tr_b16 v[186:187], v125 offset:3072
  s_waitcnt lgkmcnt(12)
  v_mfma_f32_16x16x32_bf16 v[52:55], v[188:191], v[140:143], v[52:55]
  s_add_u32 m0, s36, 1024
  s_nop 0
  buffer_load_dwordx4 v129, s[40:43], s33 offen lds
  v_mfma_f32_16x16x32_bf16 v[108:111], v[188:191], v[144:147], v[108:111]
  ds_read_b64_tr_b16 v[188:189], v126 offset:1024
  ds_read_b64_tr_b16 v[190:191], v126 offset:3072
  s_waitcnt vmcnt(10)
  s_waitcnt lgkmcnt(12)
  v_mfma_f32_16x16x32_bf16 v[0:3], v[164:167], v[148:151], v[0:3]
  s_add_u32 m0, s36, 2048
  s_nop 0
  buffer_load_dwordx4 v130, s[40:43], s33 offen lds
  v_mfma_f32_16x16x32_bf16 v[56:59], v[164:167], v[152:155], v[56:59]
  ds_read_b64_tr_b16 v[164:165], v124 offset:16384
  ds_read_b64_tr_b16 v[166:167], v124 offset:18432
  s_waitcnt lgkmcnt(12)
  v_mfma_f32_16x16x32_bf16 v[4:7], v[168:171], v[148:151], v[4:7]
  v_mfma_f32_16x16x32_bf16 v[60:63], v[168:171], v[152:155], v[60:63]
  ds_read_b64_tr_b16 v[168:169], v125 offset:16384
  ds_read_b64_tr_b16 v[170:171], v125 offset:18432
  s_waitcnt lgkmcnt(12)
  v_mfma_f32_16x16x32_bf16 v[8:11], v[172:175], v[148:151], v[8:11]
  v_mfma_f32_16x16x32_bf16 v[64:67], v[172:175], v[152:155], v[64:67]
  ds_read_b64_tr_b16 v[172:173], v126 offset:16384
  ds_read_b64_tr_b16 v[174:175], v126 offset:18432
  s_waitcnt lgkmcnt(12)
  v_mfma_f32_16x16x32_bf16 v[12:15], v[176:179], v[148:151], v[12:15]
  s_add_u32 m0, s36, 3072
  s_nop 0
  buffer_load_dwordx4 v131, s[40:43], s33 offen lds
  s_add_u32 s33, s33, 458752
  v_mfma_f32_16x16x32_bf16 v[68:71], v[176:179], v[152:155], v[68:71]
  s_cmp_lg_u32 s34, s58
  s_cbranch_scc1 L_gemm3_kernel_hk2
  s_lshl_b32 s28, s20, 8
  s_add_u32 s28, s28, 131072
  v_lshlrev_b32 v115, 2, v112
  v_add_u32 v115, s28, v115
  ds_read_b32 v192, v115 offset:0
  ds_read_b32 v193, v115 offset:1024
  ds_read_b32 v194, v115 offset:2048
  ds_read_b32 v195, v115 offset:3072
  ds_read_b32 v196, v115 offset:4096
  ds_read_b32 v197, v115 offset:5120
  ds_read_b32 v198, v115 offset:6144
  ds_read_b32 v199, v115 offset:7168
  ds_read_b32 v200, v115 offset:8192
  ds_read_b32 v201, v115 offset:9216
  ds_read_b32 v202, v115 offset:10240
  ds_read_b32 v203, v115 offset:11264
  ds_read_b32 v204, v115 offset:12288
  ds_read_b32 v205, v115 offset:13312
  ds_read_b32 v206, v115 offset:14336
  ds_read_b32 v207, v115 offset:15360
  s_waitcnt lgkmcnt(0)
  v_pk_add_f32 v[192:193], v[192:193], v[200:201]
  v_pk_add_f32 v[194:195], v[194:195], v[202:203]
  v_pk_add_f32 v[196:197], v[196:197], v[204:205]
  v_pk_add_f32 v[198:199], v[198:199], v[206:207]
  v_pk_add_f32 v[192:193], v[192:193], v[196:197]
  v_pk_add_f32 v[194:195], v[194:195], v[198:199]
  v_pk_add_f32 v[192:193], v[192:193], v[194:195]
  v_add_f32 v192, v192, v193
  ds_write_b32 v115, v192
  s_waitcnt lgkmcnt(0)
L_gemm3_kernel_hk2:
  ds_read_b64_tr_b16 v[176:177], v127 offset:16384
  ds_read_b64_tr_b16 v[178:179], v127 offset:18432
  s_waitcnt lgkmcnt(12)
  v_mfma_f32_16x16x32_bf16 v[16:19], v[180:183], v[148:151], v[16:19]
  v_mfma_f32_16x16x32_bf16 v[72:75], v[180:183], v[152:155], v[72:75]
  ds_read_b64_tr_b16 v[180:181], v124 offset:17408
  ds_read_b64_tr_b16 v[182:183], v124 offset:19456
  s_waitcnt lgkmcnt(12)
  v_mfma_f32_16x16x32_bf16 v[20:23], v[184:187], v[148:151], v[20:23]
  v_mfma_f32_16x16x32_bf16 v[76:79], v[184:187], v[152:155], v[76:79]
  ds_read_b64_tr_b16 v[184:185], v125 offset:17408
  ds_read_b64_tr_b16 v[186:187], v125 offset:19456
  s_waitcnt lgkmcnt(12)
  v_mfma_f32_16x16x32_bf16 v[24:27], v[188:191], v[148:151], v[24:27]
  buffer_load_dwordx4 v[140:143], v113, s[8:11], s32 offen offset:0
  v_mfma_f32_16x16x32_bf16 v[80:83], v[188:191], v[152:155], v[80:83]
  ds_read_b64_tr_b16 v[188:189], v126 offset:17408
  ds_read_b64_tr_b16 v[190:191], v126 offset:19456
  s_waitcnt lgkmcnt(12)
  v_mfma_f32_16x16x32_bf16 v[28:31], v[164:167], v[148:151], v[28:31]
  v_mfma_f32_16x16x32_bf16 v[84:87], v[164:167], v[152:155], v[84:87]
  ds_read_b64_tr_b16 v[164:165], v124 offset:8192
  ds_read_b64_tr_b16 v[166:167], v124 offset:10240
  s_waitcnt lgkmcnt(12)
  v_mfma_f32_16x16x32_bf16 v[32:35], v[168:171], v[148:151], v[32:35]
  v_mfma_f32_16x16x32_bf16 v[88:91], v[168:171], v[152:155], v[88:91]
  ds_read_b64_tr_b16 v[168:169], v125 offset:8192
  ds_read_b64_tr_b16 v[170:171], v125 offset:10240
  s_waitcnt lgkmcnt(12)
  v_mfma_f32_16x16x32_bf16 v[36:39], v[172:175], v[148:151], v[36:39]
  buffer_load_dwordx4 v[144:147], v113, s[8:11], s32 offen offset:1024
  s_add_u32 s32, s32, 131072
  v_mfma_f32_16x16x32_bf16 v[92:95], v[172:175], v[152:155], v[92:95]
  ds_read_b64_tr_b16 v[172:173], v126 offset:8192
  ds_read_b64_tr_b16 v[174:175], v126 offset:10240
  s_waitcnt lgkmcnt(12)
  v_mfma_f32_16x16x32_bf16 v[40:43], v[176:179], v[148:151], v[40:43]
  v_mfma_f32_16x16x32_bf16 v[96:99], v[176:179], v[152:155], v[96:99]
  ds_read_b64_tr_b16 v[176:177], v127 offset:8192
  ds_read_b64_tr_b16 v[178:179], v127 offset:10240
  s_waitcnt lgkmcnt(12)
  v_mfma_f32_16x16x32_bf16 v[44:47], v[180:183], v[148:151], v[44:47]
  v_mfma_f32_16x16x32_bf16 v[100:103], v[180:183], v[152:155], v[100:103]
  ds_read_b64_tr_b16 v[180:181], v124 offset:9216
  ds_read_b64_tr_b16 v[182:183], v124 offset:11264
  s_waitcnt lgkmcnt(12)
  v_mfma_f32_16x16x32_bf16 v[48:51], v[184:187], v[148:151], v[48:51]
  v_mfma_f32_16x16x32_bf16 v[104:107], v[184:187], v[152:155], v[104:107]
  ds_read_b64_tr_b16 v[184:185], v125 offset:9216
  ds_read_b64_tr_b16 v[186:187], v125 offset:11264
  s_waitcnt lgkmcnt(12)
  v_mfma_f32_16x16x32_bf16 v[52:55], v[188:191], v[148:151], v[52:55]
  v_mfma_f32_16x16x32_bf16 v[108:111], v[188:191], v[152:155], v[108:111]
  ds_read_b64_tr_b16 v[188:189], v126 offset:9216
  ds_read_b64_tr_b16 v[190:191], v126 offset:11264
  s_waitcnt vmcnt(8)
  s_waitcnt lgkmcnt(12)
  v_mfma_f32_16x16x32_bf16 v[0:3], v[164:167], v[156:159], v[0:3]
  v_mfma_f32_16x16x32_bf16 v[56:59], v[164:167], v[160:163], v[56:59]
  ds_read_b64_tr_b16 v[164:165], v124 offset:24576
  ds_read_b64_tr_b16 v[166:167], v124 offset:26624
  s_waitcnt lgkmcnt(12)
  v_mfma_f32_16x16x32_bf16 v[4:7], v[168:171], v[156:159], v[4:7]
  buffer_load_dwordx4 v[148:151], v113, s[8:11], s32 offen offset:0
  v_mfma_f32_16x16x32_bf16 v[60:63], v[168:171], v[160:163], v[60:63]
  ds_read_b64_tr_b16 v[168:169], v125 offset:24576
  ds_read_b64_tr_b16 v[170:171], v125 offset:26624
  s_waitcnt lgkmcnt(12)
  v_mfma_f32_16x16x32_bf16 v[8:11], v[172:175], v[156:159], v[8:11]
  v_mfma_f32_16x16x32_bf16 v[64:67], v[172:175], v[160:163], v[64:67]
  ds_read_b64_tr_b16 v[172:173], v126 offset:24576
  ds_read_b64_tr_b16 v[174:175], v126 offset:26624
  s_waitcnt lgkmcnt(12)
  v_mfma_f32_16x16x32_bf16 v[12:15], v[176:179], v[156:159], v[12:15]
  v_mfma_f32_16x16x32_bf16 v[68:71], v[176:179], v[160:163], v[68:71]
  ds_read_b64_tr_b16 v[176:177], v127 offset:24576
  ds_read_b64_tr_b16 v[178:179], v127 offset:26624
  s_waitcnt lgkmcnt(12)
  v_mfma_f32_16x16x32_bf16 v[16:19], v[180:183], v[156:159], v[16:19]
  buffer_load_dwordx4 v[152:155], v113, s[8:11], s32 offen offset:1024
  s_add_u32 s32, s32, 131072
  v_mfma_f32_16x16x32_bf16 v[72:75], v[180:183], v[160:163], v[72:75]
  ds_read_b64_tr_b16 v[180:181], v124 offset:25600
  ds_read_b64_tr_b16 v[182:183], v124 offset:27648
  s_waitcnt lgkmcnt(12)
  v_mfma_f32_16x16x32_bf16 v[20:23], v[184:187], v[156:159], v[20:23]
  v_mfma_f32_16x16x32_bf16 v[76:79], v[184:187], v[160:163], v[76:79]
  ds_read_b64_tr_b16 v[184:185], v125 offset:25600
  ds_read_b64_tr_b16 v[186:187], v125 offset:27648
  s_waitcnt lgkmcnt(12)
  v_mfma_f32_16x16x32_bf16 v[24:27], v[188:191], v[156:159], v[24:27]
  v_mfma_f32_16x16x32_bf16 v[80:83], v[188:191], v[160:163], v[80:83]
  ds_read_b64_tr_b16 v[188:189], v126 offset:25600
  ds_read_b64_tr_b16 v[190:191], v126 offset:27648
  s_waitcnt lgkmcnt(12)
  v_mfma_f32_16x16x32_bf16 v[28:31], v[164:167], v[156:159], v[28:31]
  v_mfma_f32_16x16x32_bf16 v[84:87], v[164:167], v[160:163], v[84:87]
  s_barrier
  v_add_u32 v120, s35, v114
  v_xor_b32 v121, 32, v120
  v_xor_b32 v122, 64, v120
  v_xor_b32 v123, 96, v120
  s_add_u32 s35, s35, 32768
  s_cmp_eq_u32 s35, 131072
  s_cselect_b32 s35, 0, s35
  s_add_u32 s36, s37, s39
  s_add_u32 s37, s37, 32768
  s_cmp_eq_u32 s37, 131072
  s_cselect_b32 s37, 0, s37
  ds_read_b64_tr_b16 v[164:165], v120 offset:0
  ds_read_b64_tr_b16 v[166:167], v120 offset:2048
  s_waitcnt lgkmcnt(12)
  v_mfma_f32_16x16x32_bf16 v[32:35], v[168:171], v[156:159], v[32:35]
  v_mfma_f32_16x16x32_bf16 v[88:91], v[168:171], v[160:163], v[88:91]
  ds_read_b64_tr_b16 v[168:169], v121 offset:0
  ds_read_b64_tr_b16 v[170:171], v121 offset:2048
  s_waitcnt lgkmcnt(12)
  v_mfma_f32_16x16x32_bf16 v[36:39], v[172:175], v[156:159], v[36:39]
  v_mfma_f32_16x16x32_bf16 v[92:95], v[172:175], v[160:163], v[92:95]
  ds_read_b64_tr_b16 v[172:173], v122 offset:0
  ds_read_b64_tr_b16 v[174:175], v122 offset:2048
  s_waitcnt lgkmcnt(12)
  v_mfma_f32_16x16x32_bf16 v[40:43], v[176:179], v[156:159], v[40:43]
  s_add_u32 m0, s36, 0
  s_nop 0
  buffer_load_dwordx4 v128, s[40:43], s33 offen lds
  v_mfma_f32_16x16x32_bf16 v[96:99], v[176:179], v[160:163], v[96:99]
  ds_read_b64_tr_b16 v[176:177], v123 offset:0
  ds_read_b64_tr_b16 v[178:179], v123 offset:2048
  s_waitcnt lgkmcnt(12)
  v_mfma_f32_16x16x32_bf16 v[44:47], v[180:183], v[156:159], v[44:47]
  v_mfma_f32_16x16x32_bf16 v[100:103], v[180:183], v[160:163], v[100:103]
  ds_read_b64_tr_b16 v[180:181], v120 offset:1024
  ds_read_b64_tr_b16 v[182:183], v120 offset:3072
  s_waitcnt lgkmcnt(12)
  v_mfma_f32_16x16x32_bf16 v[48:51], v[184:187], v[156:159], v[48:51]
  v_mfma_f32_16x16x32_bf16 v[104:107], v[184:187], v[160:163], v[104:107]
  ds_read_b64_tr_b16 v[184:185], v121 offset:1024
  ds_read_b64_tr_b16 v[186:187], v121 offset:3072
  s_waitcnt lgkmcnt(12)
  v_mfma_f32_16x16x32_bf16 v[52:55], v[188:191], v[156:159], v[52:55]
  s_add_u32 m0, s36, 1024
  s_nop 0
  buffer_load_dwordx4 v129, s[40:43], s33 offen lds
  v_mfma_f32_16x16x32_bf16 v[108:111], v[188:191], v[160:163], v[108:111]
  s_sub_u32 s34, s34, 1
  s_cmp_lg_u32 s34, 0
  s_cbranch_scc1 L_gemm3_kernel_loop0
L_gemm3_kernel_join:
  s_waitcnt vmcnt(0) lgkmcnt(0)
  s_nop 7
  s_nop 7
  s_add_u32 s12, s82, 25165824
  s_addc_u32 s13, s83, 0
  s_mov_b32 s14, 14680064
  s_mov_b32 s15, 0x20000
  v_lshrrev_b32 v115, 4, v112
  v_lshlrev_b32 v115, 4, v115
  v_add_u32 v115, 131072, v115
  ds_read_b128 v[132:135], v115 offset:0
  ds_read_b128 v[136:139], v115 offset:512
  v_pk_add_f32 v[192:193], v[192:193], v[194:195]
  v_pk_add_f32 v[196:197], v[196:197], v[198:199]
  v_pk_add_f32 v[192:193], v[192:193], v[196:197]
  v_mov_b32 v194, v192
  s_nop 1
  v_permlane32_swap_b32 v192, v194
  v_add_f32 v192, v192, v194
  v_mov_b32 v194, v192
  s_nop 1
  v_permlane16_swap_b32 v192, v194
  v_add_f32 v192, v192, v194
  v_mov_b32 v194, v193
  s_nop 1
  v_permlane32_swap_b32 v193, v194
  v_add_f32 v193, v193, v194
  v_mov_b32 v194, v193
  s_nop 1
  v_permlane16_swap_b32 v193, v194
  v_add_f32 v193, v193, v194
  v_mul_f32 v192, 0xba800000, v192
  v_mul_f32 v193, 0x3a800000, v193
  v_fma_f32 v193, -v192, v192, v193
  v_max_f32 v193, 0, v193
  v_add_f32 v194, 0x3727c5ac, v193
  v_rsq_f32 v193, v194
  s_nop 0
  v_mul_f32 v194, v194, v193
  v_pk_add_f32 v[200:201], v[200:201], v[202:203]
  v_pk_add_f32 v[204:205], v[204:205], v[206:207]
  v_pk_add_f32 v[200:201], v[200:201], v[204:205]
  v_mov_b32 v202, v200
  s_nop 1
  v_permlane32_swap_b32 v200, v202
  v_add_f32 v200, v200, v202
  v_mov_b32 v202, v200
  s_nop 1
  v_permlane16_swap_b32 v200, v202
  v_add_f32 v200, v200, v202
  v_mov_b32 v202, v201
  s_nop 1
  v_permlane32_swap_b32 v201, v202
  v_add_f32 v201, v201, v202
  v_mov_b32 v202, v201
  s_nop 1
  v_permlane16_swap_b32 v201, v202
  v_add_f32 v201, v201, v202
  v_mul_f32 v200, 0xba800000, v200
  v_mul_f32 v201, 0x3a800000, v201
  v_fma_f32 v201, -v200, v200, v201
  v_max_f32 v201, 0, v201
  v_add_f32 v202, 0x3727c5ac, v201
  v_rsq_f32 v201, v202
  s_nop 0
  v_mul_f32 v202, v202, v201
  v_mov_b32 v196, 0xc0135761
  v_mov_b32 v197, 0xbdd2d3e8
  s_mul_i32 s21, s17, 7
  s_lshr_b32 s21, s21, 1
  s_lshl_b32 s21, s21, 7
  s_add_u32 s21, s21, s18
  s_lshl_b32 s21, s21, 10
  s_and_b32 s22, s17, 1
  s_cmp_eq_u32 s22, 1
  s_cbranch_scc1 L_gemm3_kernel_odd
  ds_read_b128 v[148:151], v115 offset:64
  ds_read_b128 v[152:155], v115 offset:576
  s_waitcnt lgkmcnt(2)
  v_pk_fma_f32 v[0:1], v[192:193], v[132:133], v[0:1] op_sel_hi:[0,1,1]
  v_pk_fma_f32 v[2:3], v[192:193], v[134:135], v[2:3] op_sel_hi:[0,1,1]
  v_pk_fma_f32 v[28:29], v[192:193], v[136:137], v[28:29] op_sel_hi:[0,1,1]
  v_pk_fma_f32 v[30:31], v[192:193], v[138:139], v[30:31] op_sel_hi:[0,1,1]
  v_pk_mul_f32 v[0:1], v[0:1], v[192:193] op_sel:[0,1] op_sel_hi:[1,1]
  v_pk_mul_f32 v[2:3], v[2:3], v[192:193] op_sel:[0,1] op_sel_hi:[1,1]
  v_pk_mul_f32 v[164:165], v[0:1], v[0:1]
  v_pk_mul_f32 v[166:167], v[2:3], v[2:3]
  v_pk_fma_f32 v[164:165], v[164:165], v[196:197], v[196:197] op_sel:[0,1,0] op_sel_hi:[1,1,0]
  v_pk_fma_f32 v[166:167], v[166:167], v[196:197], v[196:197] op_sel:[0,1,0] op_sel_hi:[1,1,0]
  v_pk_mul_f32 v[164:165], v[164:165], v[0:1]
  v_pk_mul_f32 v[166:167], v[166:167], v[2:3]
  v_exp_f32 v164, v164
  v_exp_f32 v165, v165
  v_exp_f32 v166, v166
  v_exp_f32 v167, v167
  v_pk_mul_f32 v[28:29], v[28:29], v[0:1]
  v_pk_mul_f32 v[30:31], v[30:31], v[2:3]
  v_pk_fma_f32 v[164:165], v[164:165], v[194:195], v[194:195] op_sel_hi:[1,0,0]
  v_pk_fma_f32 v[166:167], v[166:167], v[194:195], v[194:195] op_sel_hi:[1,0,0]
  v_rcp_f32 v164, v164
  v_rcp_f32 v165, v165
  v_rcp_f32 v166, v166
  v_rcp_f32 v167, v167
  s_nop 0
  v_pk_mul_f32 v[28:29], v[28:29], v[164:165]
  v_pk_mul_f32 v[30:31], v[30:31], v[166:167]
  v_cvt_pk_bf16_f32 v0, v28, v29
  v_cvt_pk_bf16_f32 v1, v30, v31
  v_pk_fma_f32 v[56:57], v[200:201], v[132:133], v[56:57] op_sel_hi:[0,1,1]
  v_pk_fma_f32 v[58:59], v[200:201], v[134:135], v[58:59] op_sel_hi:[0,1,1]
  v_pk_fma_f32 v[84:85], v[200:201], v[136:137], v[84:85] op_sel_hi:[0,1,1]
  v_pk_fma_f32 v[86:87], v[200:201], v[138:139], v[86:87] op_sel_hi:[0,1,1]
  v_pk_mul_f32 v[56:57], v[56:57], v[200:201] op_sel:[0,1] op_sel_hi:[1,1]
  v_pk_mul_f32 v[58:59], v[58:59], v[200:201] op_sel:[0,1] op_sel_hi:[1,1]
  v_pk_mul_f32 v[164:165], v[56:57], v[56:57]
  v_pk_mul_f32 v[166:167], v[58:59], v[58:59]
  v_pk_fma_f32 v[164:165], v[164:165], v[196:197], v[196:197] op_sel:[0,1,0] op_sel_hi:[1,1,0]
  v_pk_fma_f32 v[166:167], v[166:167], v[196:197], v[196:197] op_sel:[0,1,0] op_sel_hi:[1,1,0]
  v_pk_mul_f32 v[164:165], v[164:165], v[56:57]
  v_pk_mul_f32 v[166:167], v[166:167], v[58:59]
  v_exp_f32 v164, v164
  v_exp_f32 v165, v165
  v_exp_f32 v166, v166
  v_exp_f32 v167, v167
  v_pk_mul_f32 v[84:85], v[84:85], v[56:57]
  v_pk_mul_f32 v[86:87], v[86:87], v[58:59]
  v_pk_fma_f32 v[164:165], v[164:165], v[202:203], v[202:203] op_sel_hi:[1,0,0]
  v_pk_fma_f32 v[166:167], v[166:167], v[202:203], v[202:203] op_sel_hi:[1,0,0]
  v_rcp_f32 v164, v164
  v_rcp_f32 v165, v165
  v_rcp_f32 v166, v166
  v_rcp_f32 v167, v167
  s_nop 0
  v_pk_mul_f32 v[84:85], v[84:85], v[164:165]
  v_pk_mul_f32 v[86:87], v[86:87], v[166:167]
  v_cvt_pk_bf16_f32 v56, v84, v85
  v_cvt_pk_bf16_f32 v57, v86, v87
  ds_read_b128 v[132:135], v115 offset:128
  ds_read_b128 v[136:139], v115 offset:640
  s_waitcnt lgkmcnt(2)
  v_pk_fma_f32 v[4:5], v[192:193], v[148:149], v[4:5] op_sel_hi:[0,1,1]
  v_pk_fma_f32 v[6:7], v[192:193], v[150:151], v[6:7] op_sel_hi:[0,1,1]
  v_pk_fma_f32 v[32:33], v[192:193], v[152:153], v[32:33] op_sel_hi:[0,1,1]
  v_pk_fma_f32 v[34:35], v[192:193], v[154:155], v[34:35] op_sel_hi:[0,1,1]
  v_pk_mul_f32 v[4:5], v[4:5], v[192:193] op_sel:[0,1] op_sel_hi:[1,1]
  v_pk_mul_f32 v[6:7], v[6:7], v[192:193] op_sel:[0,1] op_sel_hi:[1,1]
  v_pk_mul_f32 v[164:165], v[4:5], v[4:5]
  v_pk_mul_f32 v[166:167], v[6:7], v[6:7]
  v_pk_fma_f32 v[164:165], v[164:165], v[196:197], v[196:197] op_sel:[0,1,0] op_sel_hi:[1,1,0]
  v_pk_fma_f32 v[166:167], v[166:167], v[196:197], v[196:197] op_sel:[0,1,0] op_sel_hi:[1,1,0]
  v_pk_mul_f32 v[164:165], v[164:165], v[4:5]
  v_pk_mul_f32 v[166:167], v[166:167], v[6:7]
  v_exp_f32 v164, v164
  v_exp_f32 v165, v165
  v_exp_f32 v166, v166
  v_exp_f32 v167, v167
  v_pk_mul_f32 v[32:33], v[32:33], v[4:5]
  v_pk_mul_f32 v[34:35], v[34:35], v[6:7]
  v_pk_fma_f32 v[164:165], v[164:165], v[194:195], v[194:195] op_sel_hi:[1,0,0]
  v_pk_fma_f32 v[166:167], v[166:167], v[194:195], v[194:195] op_sel_hi:[1,0,0]
  v_rcp_f32 v164, v164
  v_rcp_f32 v165, v165
  v_rcp_f32 v166, v166
  v_rcp_f32 v167, v167
  s_nop 0
  v_pk_mul_f32 v[32:33], v[32:33], v[164:165]
  v_pk_mul_f32 v[34:35], v[34:35], v[166:167]
  v_cvt_pk_bf16_f32 v2, v32, v33
  v_cvt_pk_bf16_f32 v3, v34, v35
  s_nop 1
  v_permlane16_swap_b32 v0, v2
  v_permlane16_swap_b32 v1, v3
  buffer_store_dwordx4 v[0:3], v113, s[12:15], s21 offen offset:0 sc0 sc1
  v_pk_fma_f32 v[60:61], v[200:201], v[148:149], v[60:61] op_sel_hi:[0,1,1]
  v_pk_fma_f32 v[62:63], v[200:201], v[150:151], v[62:63] op_sel_hi:[0,1,1]
  v_pk_fma_f32 v[88:89], v[200:201], v[152:153], v[88:89] op_sel_hi:[0,1,1]
  v_pk_fma_f32 v[90:91], v[200:201], v[154:155], v[90:91] op_sel_hi:[0,1,1]
  v_pk_mul_f32 v[60:61], v[60:61], v[200:201] op_sel:[0,1] op_sel_hi:[1,1]
  v_pk_mul_f32 v[62:63], v[62:63], v[200:201] op_sel:[0,1] op_sel_hi:[1,1]
  v_pk_mul_f32 v[164:165], v[60:61], v[60:61]
  v_pk_mul_f32 v[166:167], v[62:63], v[62:63]
  v_pk_fma_f32 v[164:165], v[164:165], v[196:197], v[196:197] op_sel:[0,1,0] op_sel_hi:[1,1,0]
  v_pk_fma_f32 v[166:167], v[166:167], v[196:197], v[196:197] op_sel:[0,1,0] op_sel_hi:[1,1,0]
  v_pk_mul_f32 v[164:165], v[164:165], v[60:61]
  v_pk_mul_f32 v[166:167], v[166:167], v[62:63]
  v_exp_f32 v164, v164
  v_exp_f32 v165, v165
  v_exp_f32 v166, v166
  v_exp_f32 v167, v167
  v_pk_mul_f32 v[88:89], v[88:89], v[60:61]
  v_pk_mul_f32 v[90:91], v[90:91], v[62:63]
  v_pk_fma_f32 v[164:165], v[164:165], v[202:203], v[202:203] op_sel_hi:[1,0,0]
  v_pk_fma_f32 v[166:167], v[166:167], v[202:203], v[202:203] op_sel_hi:[1,0,0]
  v_rcp_f32 v164, v164
  v_rcp_f32 v165, v165
  v_rcp_f32 v166, v166
  v_rcp_f32 v167, v167
  s_nop 0
  v_pk_mul_f32 v[88:89], v[88:89], v[164:165]
  v_pk_mul_f32 v[90:91], v[90:91], v[166:167]
  v_cvt_pk_bf16_f32 v58, v88, v89
  v_cvt_pk_bf16_f32 v59, v90, v91
  s_nop 1
  v_permlane16_swap_b32 v56, v58
  v_permlane16_swap_b32 v57, v59
  buffer_store_dwordx4 v[56:59], v113, s[12:15], s21 offen offset:1024 sc0 sc1
  s_add_u32 s21, s21, 131072
  ds_read_b128 v[148:151], v115 offset:192
  ds_read_b128 v[152:155], v115 offset:704
  s_waitcnt lgkmcnt(2)
  v_pk_fma_f32 v[8:9], v[192:193], v[132:133], v[8:9] op_sel_hi:[0,1,1]
  v_pk_fma_f32 v[10:11], v[192:193], v[134:135], v[10:11] op_sel_hi:[0,1,1]
  v_pk_fma_f32 v[36:37], v[192:193], v[136:137], v[36:37] op_sel_hi:[0,1,1]
  v_pk_fma_f32 v[38:39], v[192:193], v[138:139], v[38:39] op_sel_hi:[0,1,1]
  v_pk_mul_f32 v[8:9], v[8:9], v[192:193] op_sel:[0,1] op_sel_hi:[1,1]
  v_pk_mul_f32 v[10:11], v[10:11], v[192:193] op_sel:[0,1] op_sel_hi:[1,1]
  v_pk_mul_f32 v[164:165], v[8:9], v[8:9]
  v_pk_mul_f32 v[166:167], v[10:11], v[10:11]
  v_pk_fma_f32 v[164:165], v[164:165], v[196:197], v[196:197] op_sel:[0,1,0] op_sel_hi:[1,1,0]
  v_pk_fma_f32 v[166:167], v[166:167], v[196:197], v[196:197] op_sel:[0,1,0] op_sel_hi:[1,1,0]
  v_pk_mul_f32 v[164:165], v[164:165], v[8:9]
  v_pk_mul_f32 v[166:167], v[166:167], v[10:11]
  v_exp_f32 v164, v164
  v_exp_f32 v165, v165
  v_exp_f32 v166, v166
  v_exp_f32 v167, v167
  v_pk_mul_f32 v[36:37], v[36:37], v[8:9]
  v_pk_mul_f32 v[38:39], v[38:39], v[10:11]
  v_pk_fma_f32 v[164:165], v[164:165], v[194:195], v[194:195] op_sel_hi:[1,0,0]
  v_pk_fma_f32 v[166:167], v[166:167], v[194:195], v[194:195] op_sel_hi:[1,0,0]
  v_rcp_f32 v164, v164
  v_rcp_f32 v165, v165
  v_rcp_f32 v166, v166
  v_rcp_f32 v167, v167
  s_nop 0
  v_pk_mul_f32 v[36:37], v[36:37], v[164:165]
  v_pk_mul_f32 v[38:39], v[38:39], v[166:167]
  v_cvt_pk_bf16_f32 v8, v36, v37
  v_cvt_pk_bf16_f32 v9, v38, v39
  v_pk_fma_f32 v[64:65], v[200:201], v[132:133], v[64:65] op_sel_hi:[0,1,1]
  v_pk_fma_f32 v[66:67], v[200:201], v[134:135], v[66:67] op_sel_hi:[0,1,1]
  v_pk_fma_f32 v[92:93], v[200:201], v[136:137], v[92:93] op_sel_hi:[0,1,1]
  v_pk_fma_f32 v[94:95], v[200:201], v[138:139], v[94:95] op_sel_hi:[0,1,1]
  v_pk_mul_f32 v[64:65], v[64:65], v[200:201] op_sel:[0,1] op_sel_hi:[1,1]
  v_pk_mul_f32 v[66:67], v[66:67], v[200:201] op_sel:[0,1] op_sel_hi:[1,1]
  v_pk_mul_f32 v[164:165], v[64:65], v[64:65]
  v_pk_mul_f32 v[166:167], v[66:67], v[66:67]
  v_pk_fma_f32 v[164:165], v[164:165], v[196:197], v[196:197] op_sel:[0,1,0] op_sel_hi:[1,1,0]
  v_pk_fma_f32 v[166:167], v[166:167], v[196:197], v[196:197] op_sel:[0,1,0] op_sel_hi:[1,1,0]
  v_pk_mul_f32 v[164:165], v[164:165], v[64:65]
  v_pk_mul_f32 v[166:167], v[166:167], v[66:67]
  v_exp_f32 v164, v164
  v_exp_f32 v165, v165
  v_exp_f32 v166, v166
  v_exp_f32 v167, v167
  v_pk_mul_f32 v[92:93], v[92:93], v[64:65]
  v_pk_mul_f32 v[94:95], v[94:95], v[66:67]
  v_pk_fma_f32 v[164:165], v[164:165], v[202:203], v[202:203] op_sel_hi:[1,0,0]
  v_pk_fma_f32 v[166:167], v[166:167], v[202:203], v[202:203] op_sel_hi:[1,0,0]
  v_rcp_f32 v164, v164
  v_rcp_f32 v165, v165
  v_rcp_f32 v166, v166
  v_rcp_f32 v167, v167
  s_nop 0
  v_pk_mul_f32 v[92:93], v[92:93], v[164:165]
  v_pk_mul_f32 v[94:95], v[94:95], v[166:167]
  v_cvt_pk_bf16_f32 v64, v92, v93
  v_cvt_pk_bf16_f32 v65, v94, v95
  ds_read_b128 v[132:135], v115 offset:256
  ds_read_b128 v[136:139], v115 offset:768
  s_waitcnt lgkmcnt(2)
  v_pk_fma_f32 v[12:13], v[192:193], v[148:149], v[12:13] op_sel_hi:[0,1,1]
  v_pk_fma_f32 v[14:15], v[192:193], v[150:151], v[14:15] op_sel_hi:[0,1,1]
  v_pk_fma_f32 v[40:41], v[192:193], v[152:153], v[40:41] op_sel_hi:[0,1,1]
  v_pk_fma_f32 v[42:43], v[192:193], v[154:155], v[42:43] op_sel_hi:[0,1,1]
  v_pk_mul_f32 v[12:13], v[12:13], v[192:193] op_sel:[0,1] op_sel_hi:[1,1]
  v_pk_mul_f32 v[14:15], v[14:15], v[192:193] op_sel:[0,1] op_sel_hi:[1,1]
  v_pk_mul_f32 v[164:165], v[12:13], v[12:13]
  v_pk_mul_f32 v[166:167], v[14:15], v[14:15]
  v_pk_fma_f32 v[164:165], v[164:165], v[196:197], v[196:197] op_sel:[0,1,0] op_sel_hi:[1,1,0]
  v_pk_fma_f32 v[166:167], v[166:167], v[196:197], v[196:197] op_sel:[0,1,0] op_sel_hi:[1,1,0]
  v_pk_mul_f32 v[164:165], v[164:165], v[12:13]
  v_pk_mul_f32 v[166:167], v[166:167], v[14:15]
  v_exp_f32 v164, v164
  v_exp_f32 v165, v165
  v_exp_f32 v166, v166
  v_exp_f32 v167, v167
  v_pk_mul_f32 v[40:41], v[40:41], v[12:13]
  v_pk_mul_f32 v[42:43], v[42:43], v[14:15]
  v_pk_fma_f32 v[164:165], v[164:165], v[194:195], v[194:195] op_sel_hi:[1,0,0]
  v_pk_fma_f32 v[166:167], v[166:167], v[194:195], v[194:195] op_sel_hi:[1,0,0]
  v_rcp_f32 v164, v164
  v_rcp_f32 v165, v165
  v_rcp_f32 v166, v166
  v_rcp_f32 v167, v167
  s_nop 0
  v_pk_mul_f32 v[40:41], v[40:41], v[164:165]
  v_pk_mul_f32 v[42:43], v[42:43], v[166:167]
  v_cvt_pk_bf16_f32 v10, v40, v41
  v_cvt_pk_bf16_f32 v11, v42, v43
  s_nop 1
  v_permlane16_swap_b32 v8, v10
  v_permlane16_swap_b32 v9, v11
  buffer_store_dwordx4 v[8:11], v113, s[12:15], s21 offen offset:0 sc0 sc1
  v_pk_fma_f32 v[68:69], v[200:201], v[148:149], v[68:69] op_sel_hi:[0,1,1]
  v_pk_fma_f32 v[70:71], v[200:201], v[150:151], v[70:71] op_sel_hi:[0,1,1]
  v_pk_fma_f32 v[96:97], v[200:201], v[152:153], v[96:97] op_sel_hi:[0,1,1]
  v_pk_fma_f32 v[98:99], v[200:201], v[154:155], v[98:99] op_sel_hi:[0,1,1]
  v_pk_mul_f32 v[68:69], v[68:69], v[200:201] op_sel:[0,1] op_sel_hi:[1,1]
  v_pk_mul_f32 v[70:71], v[70:71], v[200:201] op_sel:[0,1] op_sel_hi:[1,1]
  v_pk_mul_f32 v[164:165], v[68:69], v[68:69]
  v_pk_mul_f32 v[166:167], v[70:71], v[70:71]
  v_pk_fma_f32 v[164:165], v[164:165], v[196:197], v[196:197] op_sel:[0,1,0] op_sel_hi:[1,1,0]
  v_pk_fma_f32 v[166:167], v[166:167], v[196:197], v[196:197] op_sel:[0,1,0] op_sel_hi:[1,1,0]
  v_pk_mul_f32 v[164:165], v[164:165], v[68:69]
  v_pk_mul_f32 v[166:167], v[166:167], v[70:71]
  v_exp_f32 v164, v164
  v_exp_f32 v165, v165
  v_exp_f32 v166, v166
  v_exp_f32 v167, v167
  v_pk_mul_f32 v[96:97], v[96:97], v[68:69]
  v_pk_mul_f32 v[98:99], v[98:99], v[70:71]
  v_pk_fma_f32 v[164:165], v[164:165], v[202:203], v[202:203] op_sel_hi:[1,0,0]
  v_pk_fma_f32 v[166:167], v[166:167], v[202:203], v[202:203] op_sel_hi:[1,0,0]
  v_rcp_f32 v164, v164
  v_rcp_f32 v165, v165
  v_rcp_f32 v166, v166
  v_rcp_f32 v167, v167
  s_nop 0
  v_pk_mul_f32 v[96:97], v[96:97], v[164:165]
  v_pk_mul_f32 v[98:99], v[98:99], v[166:167]
  v_cvt_pk_bf16_f32 v66, v96, v97
  v_cvt_pk_bf16_f32 v67, v98, v99
  s_nop 1
  v_permlane16_swap_b32 v64, v66
  v_permlane16_swap_b32 v65, v67
  buffer_store_dwordx4 v[64:67], v113, s[12:15], s21 offen offset:1024 sc0 sc1
  s_add_u32 s21, s21, 131072
  ds_read_b128 v[148:151], v115 offset:320
  ds_read_b128 v[152:155], v115 offset:832
  s_waitcnt lgkmcnt(2)
  v_pk_fma_f32 v[16:17], v[192:193], v[132:133], v[16:17] op_sel_hi:[0,1,1]
  v_pk_fma_f32 v[18:19], v[192:193], v[134:135], v[18:19] op_sel_hi:[0,1,1]
  v_pk_fma_f32 v[44:45], v[192:193], v[136:137], v[44:45] op_sel_hi:[0,1,1]
  v_pk_fma_f32 v[46:47], v[192:193], v[138:139], v[46:47] op_sel_hi:[0,1,1]
  v_pk_mul_f32 v[16:17], v[16:17], v[192:193] op_sel:[0,1] op_sel_hi:[1,1]
  v_pk_mul_f32 v[18:19], v[18:19], v[192:193] op_sel:[0,1] op_sel_hi:[1,1]
  v_pk_mul_f32 v[164:165], v[16:17], v[16:17]
  v_pk_mul_f32 v[166:167], v[18:19], v[18:19]
  v_pk_fma_f32 v[164:165], v[164:165], v[196:197], v[196:197] op_sel:[0,1,0] op_sel_hi:[1,1,0]
  v_pk_fma_f32 v[166:167], v[166:167], v[196:197], v[196:197] op_sel:[0,1,0] op_sel_hi:[1,1,0]
  v_pk_mul_f32 v[164:165], v[164:165], v[16:17]
  v_pk_mul_f32 v[166:167], v[166:167], v[18:19]
  v_exp_f32 v164, v164
  v_exp_f32 v165, v165
  v_exp_f32 v166, v166
  v_exp_f32 v167, v167
  v_pk_mul_f32 v[44:45], v[44:45], v[16:17]
  v_pk_mul_f32 v[46:47], v[46:47], v[18:19]
  v_pk_fma_f32 v[164:165], v[164:165], v[194:195], v[194:195] op_sel_hi:[1,0,0]
  v_pk_fma_f32 v[166:167], v[166:167], v[194:195], v[194:195] op_sel_hi:[1,0,0]
  v_rcp_f32 v164, v164
  v_rcp_f32 v165, v165
  v_rcp_f32 v166, v166
  v_rcp_f32 v167, v167
  s_nop 0
  v_pk_mul_f32 v[44:45], v[44:45], v[164:165]
  v_pk_mul_f32 v[46:47], v[46:47], v[166:167]
  v_cvt_pk_bf16_f32 v16, v44, v45
  v_cvt_pk_bf16_f32 v17, v46, v47
  v_pk_fma_f32 v[72:73], v[200:201], v[132:133], v[72:73] op_sel_hi:[0,1,1]
  v_pk_fma_f32 v[74:75], v[200:201], v[134:135], v[74:75] op_sel_hi:[0,1,1]
  v_pk_fma_f32 v[100:101], v[200:201], v[136:137], v[100:101] op_sel_hi:[0,1,1]
  v_pk_fma_f32 v[102:103], v[200:201], v[138:139], v[102:103] op_sel_hi:[0,1,1]
  v_pk_mul_f32 v[72:73], v[72:73], v[200:201] op_sel:[0,1] op_sel_hi:[1,1]
  v_pk_mul_f32 v[74:75], v[74:75], v[200:201] op_sel:[0,1] op_sel_hi:[1,1]
  v_pk_mul_f32 v[164:165], v[72:73], v[72:73]
  v_pk_mul_f32 v[166:167], v[74:75], v[74:75]
  v_pk_fma_f32 v[164:165], v[164:165], v[196:197], v[196:197] op_sel:[0,1,0] op_sel_hi:[1,1,0]
  v_pk_fma_f32 v[166:167], v[166:167], v[196:197], v[196:197] op_sel:[0,1,0] op_sel_hi:[1,1,0]
  v_pk_mul_f32 v[164:165], v[164:165], v[72:73]
  v_pk_mul_f32 v[166:167], v[166:167], v[74:75]
  v_exp_f32 v164, v164
  v_exp_f32 v165, v165
  v_exp_f32 v166, v166
  v_exp_f32 v167, v167
  v_pk_mul_f32 v[100:101], v[100:101], v[72:73]
  v_pk_mul_f32 v[102:103], v[102:103], v[74:75]
  v_pk_fma_f32 v[164:165], v[164:165], v[202:203], v[202:203] op_sel_hi:[1,0,0]
  v_pk_fma_f32 v[166:167], v[166:167], v[202:203], v[202:203] op_sel_hi:[1,0,0]
  v_rcp_f32 v164, v164
  v_rcp_f32 v165, v165
  v_rcp_f32 v166, v166
  v_rcp_f32 v167, v167
  s_nop 0
  v_pk_mul_f32 v[100:101], v[100:101], v[164:165]
  v_pk_mul_f32 v[102:103], v[102:103], v[166:167]
  v_cvt_pk_bf16_f32 v72, v100, v101
  v_cvt_pk_bf16_f32 v73, v102, v103
  ds_read_b128 v[132:135], v115 offset:384
  ds_read_b128 v[136:139], v115 offset:896
  s_waitcnt lgkmcnt(2)
  v_pk_fma_f32 v[20:21], v[192:193], v[148:149], v[20:21] op_sel_hi:[0,1,1]
  v_pk_fma_f32 v[22:23], v[192:193], v[150:151], v[22:23] op_sel_hi:[0,1,1]
  v_pk_fma_f32 v[48:49], v[192:193], v[152:153], v[48:49] op_sel_hi:[0,1,1]
  v_pk_fma_f32 v[50:51], v[192:193], v[154:155], v[50:51] op_sel_hi:[0,1,1]
  v_pk_mul_f32 v[20:21], v[20:21], v[192:193] op_sel:[0,1] op_sel_hi:[1,1]
  v_pk_mul_f32 v[22:23], v[22:23], v[192:193] op_sel:[0,1] op_sel_hi:[1,1]
  v_pk_mul_f32 v[164:165], v[20:21], v[20:21]
  v_pk_mul_f32 v[166:167], v[22:23], v[22:23]
  v_pk_fma_f32 v[164:165], v[164:165], v[196:197], v[196:197] op_sel:[0,1,0] op_sel_hi:[1,1,0]
  v_pk_fma_f32 v[166:167], v[166:167], v[196:197], v[196:197] op_sel:[0,1,0] op_sel_hi:[1,1,0]
  v_pk_mul_f32 v[164:165], v[164:165], v[20:21]
  v_pk_mul_f32 v[166:167], v[166:167], v[22:23]
  v_exp_f32 v164, v164
  v_exp_f32 v165, v165
  v_exp_f32 v166, v166
  v_exp_f32 v167, v167
  v_pk_mul_f32 v[48:49], v[48:49], v[20:21]
  v_pk_mul_f32 v[50:51], v[50:51], v[22:23]
  v_pk_fma_f32 v[164:165], v[164:165], v[194:195], v[194:195] op_sel_hi:[1,0,0]
  v_pk_fma_f32 v[166:167], v[166:167], v[194:195], v[194:195] op_sel_hi:[1,0,0]
  v_rcp_f32 v164, v164
  v_rcp_f32 v165, v165
  v_rcp_f32 v166, v166
  v_rcp_f32 v167, v167
  s_nop 0
  v_pk_mul_f32 v[48:49], v[48:49], v[164:165]
  v_pk_mul_f32 v[50:51], v[50:51], v[166:167]
  v_cvt_pk_bf16_f32 v18, v48, v49
  v_cvt_pk_bf16_f32 v19, v50, v51
  s_nop 1
  v_permlane16_swap_b32 v16, v18
  v_permlane16_swap_b32 v17, v19
  buffer_store_dwordx4 v[16:19], v113, s[12:15], s21 offen offset:0 sc0 sc1
  v_pk_fma_f32 v[76:77], v[200:201], v[148:149], v[76:77] op_sel_hi:[0,1,1]
  v_pk_fma_f32 v[78:79], v[200:201], v[150:151], v[78:79] op_sel_hi:[0,1,1]
  v_pk_fma_f32 v[104:105], v[200:201], v[152:153], v[104:105] op_sel_hi:[0,1,1]
  v_pk_fma_f32 v[106:107], v[200:201], v[154:155], v[106:107] op_sel_hi:[0,1,1]
  v_pk_mul_f32 v[76:77], v[76:77], v[200:201] op_sel:[0,1] op_sel_hi:[1,1]
  v_pk_mul_f32 v[78:79], v[78:79], v[200:201] op_sel:[0,1] op_sel_hi:[1,1]
  v_pk_mul_f32 v[164:165], v[76:77], v[76:77]
  v_pk_mul_f32 v[166:167], v[78:79], v[78:79]
  v_pk_fma_f32 v[164:165], v[164:165], v[196:197], v[196:197] op_sel:[0,1,0] op_sel_hi:[1,1,0]
  v_pk_fma_f32 v[166:167], v[166:167], v[196:197], v[196:197] op_sel:[0,1,0] op_sel_hi:[1,1,0]
  v_pk_mul_f32 v[164:165], v[164:165], v[76:77]
  v_pk_mul_f32 v[166:167], v[166:167], v[78:79]
  v_exp_f32 v164, v164
  v_exp_f32 v165, v165
  v_exp_f32 v166, v166
  v_exp_f32 v167, v167
  v_pk_mul_f32 v[104:105], v[104:105], v[76:77]
  v_pk_mul_f32 v[106:107], v[106:107], v[78:79]
  v_pk_fma_f32 v[164:165], v[164:165], v[202:203], v[202:203] op_sel_hi:[1,0,0]
  v_pk_fma_f32 v[166:167], v[166:167], v[202:203], v[202:203] op_sel_hi:[1,0,0]
  v_rcp_f32 v164, v164
  v_rcp_f32 v165, v165
  v_rcp_f32 v166, v166
  v_rcp_f32 v167, v167
  s_nop 0
  v_pk_mul_f32 v[104:105], v[104:105], v[164:165]
  v_pk_mul_f32 v[106:107], v[106:107], v[166:167]
  v_cvt_pk_bf16_f32 v74, v104, v105
  v_cvt_pk_bf16_f32 v75, v106, v107
  s_nop 1
  v_permlane16_swap_b32 v72, v74
  v_permlane16_swap_b32 v73, v75
  buffer_store_dwordx4 v[72:75], v113, s[12:15], s21 offen offset:1024 sc0 sc1
  s_add_u32 s21, s21, 131072
  s_waitcnt lgkmcnt(0)
  v_pk_fma_f32 v[24:25], v[192:193], v[132:133], v[24:25] op_sel_hi:[0,1,1]
  v_pk_fma_f32 v[26:27], v[192:193], v[134:135], v[26:27] op_sel_hi:[0,1,1]
  v_pk_fma_f32 v[52:53], v[192:193], v[136:137], v[52:53] op_sel_hi:[0,1,1]
  v_pk_fma_f32 v[54:55], v[192:193], v[138:139], v[54:55] op_sel_hi:[0,1,1]
  v_pk_mul_f32 v[24:25], v[24:25], v[192:193] op_sel:[0,1] op_sel_hi:[1,1]
  v_pk_mul_f32 v[26:27], v[26:27], v[192:193] op_sel:[0,1] op_sel_hi:[1,1]
  v_pk_mul_f32 v[164:165], v[24:25], v[24:25]
  v_pk_mul_f32 v[166:167], v[26:27], v[26:27]
  v_pk_fma_f32 v[164:165], v[164:165], v[196:197], v[196:197] op_sel:[0,1,0] op_sel_hi:[1,1,0]
  v_pk_fma_f32 v[166:167], v[166:167], v[196:197], v[196:197] op_sel:[0,1,0] op_sel_hi:[1,1,0]
  v_pk_mul_f32 v[164:165], v[164:165], v[24:25]
  v_pk_mul_f32 v[166:167], v[166:167], v[26:27]
  v_exp_f32 v164, v164
  v_exp_f32 v165, v165
  v_exp_f32 v166, v166
  v_exp_f32 v167, v167
  v_pk_mul_f32 v[52:53], v[52:53], v[24:25]
  v_pk_mul_f32 v[54:55], v[54:55], v[26:27]
  v_pk_fma_f32 v[164:165], v[164:165], v[194:195], v[194:195] op_sel_hi:[1,0,0]
  v_pk_fma_f32 v[166:167], v[166:167], v[194:195], v[194:195] op_sel_hi:[1,0,0]
  v_rcp_f32 v164, v164
  v_rcp_f32 v165, v165
  v_rcp_f32 v166, v166
  v_rcp_f32 v167, v167
  s_nop 0
  v_pk_mul_f32 v[52:53], v[52:53], v[164:165]
  v_pk_mul_f32 v[54:55], v[54:55], v[166:167]
  v_cvt_pk_bf16_f32 v24, v52, v53
  v_cvt_pk_bf16_f32 v25, v54, v55
  s_nop 1
  v_permlane16_swap_b32 v24, v26
  v_permlane16_swap_b32 v25, v27
  s_mov_b32 exec_lo, 65535
  s_mov_b32 exec_hi, 65535
  buffer_store_dwordx4 v[24:27], v113, s[12:15], s21 offen offset:0 sc0 sc1
  s_mov_b64 exec, -1
  v_pk_fma_f32 v[80:81], v[200:201], v[132:133], v[80:81] op_sel_hi:[0,1,1]
  v_pk_fma_f32 v[82:83], v[200:201], v[134:135], v[82:83] op_sel_hi:[0,1,1]
  v_pk_fma_f32 v[108:109], v[200:201], v[136:137], v[108:109] op_sel_hi:[0,1,1]
  v_pk_fma_f32 v[110:111], v[200:201], v[138:139], v[110:111] op_sel_hi:[0,1,1]
  v_pk_mul_f32 v[80:81], v[80:81], v[200:201] op_sel:[0,1] op_sel_hi:[1,1]
  v_pk_mul_f32 v[82:83], v[82:83], v[200:201] op_sel:[0,1] op_sel_hi:[1,1]
  v_pk_mul_f32 v[164:165], v[80:81], v[80:81]
  v_pk_mul_f32 v[166:167], v[82:83], v[82:83]
  v_pk_fma_f32 v[164:165], v[164:165], v[196:197], v[196:197] op_sel:[0,1,0] op_sel_hi:[1,1,0]
  v_pk_fma_f32 v[166:167], v[166:167], v[196:197], v[196:197] op_sel:[0,1,0] op_sel_hi:[1,1,0]
  v_pk_mul_f32 v[164:165], v[164:165], v[80:81]
  v_pk_mul_f32 v[166:167], v[166:167], v[82:83]
  v_exp_f32 v164, v164
  v_exp_f32 v165, v165
  v_exp_f32 v166, v166
  v_exp_f32 v167, v167
  v_pk_mul_f32 v[108:109], v[108:109], v[80:81]
  v_pk_mul_f32 v[110:111], v[110:111], v[82:83]
  v_pk_fma_f32 v[164:165], v[164:165], v[202:203], v[202:203] op_sel_hi:[1,0,0]
  v_pk_fma_f32 v[166:167], v[166:167], v[202:203], v[202:203] op_sel_hi:[1,0,0]
  v_rcp_f32 v164, v164
  v_rcp_f32 v165, v165
  v_rcp_f32 v166, v166
  v_rcp_f32 v167, v167
  s_nop 0
  v_pk_mul_f32 v[108:109], v[108:109], v[164:165]
  v_pk_mul_f32 v[110:111], v[110:111], v[166:167]
  v_cvt_pk_bf16_f32 v80, v108, v109
  v_cvt_pk_bf16_f32 v81, v110, v111
  s_nop 1
  v_permlane16_swap_b32 v80, v82
  v_permlane16_swap_b32 v81, v83
  s_mov_b32 exec_lo, 65535
  s_mov_b32 exec_hi, 65535
  buffer_store_dwordx4 v[80:83], v113, s[12:15], s21 offen offset:1024 sc0 sc1
  s_mov_b64 exec, -1
  s_branch L_gemm3_kernel_end
L_gemm3_kernel_odd:
  ds_read_b128 v[148:151], v115 offset:64
  ds_read_b128 v[152:155], v115 offset:576
  s_waitcnt lgkmcnt(2)
  v_pk_fma_f32 v[0:1], v[192:193], v[132:133], v[0:1] op_sel_hi:[0,1,1]
  v_pk_fma_f32 v[2:3], v[192:193], v[134:135], v[2:3] op_sel_hi:[0,1,1]
  v_pk_fma_f32 v[28:29], v[192:193], v[136:137], v[28:29] op_sel_hi:[0,1,1]
  v_pk_fma_f32 v[30:31], v[192:193], v[138:139], v[30:31] op_sel_hi:[0,1,1]
  v_pk_mul_f32 v[0:1], v[0:1], v[192:193] op_sel:[0,1] op_sel_hi:[1,1]
  v_pk_mul_f32 v[2:3], v[2:3], v[192:193] op_sel:[0,1] op_sel_hi:[1,1]
  v_pk_mul_f32 v[164:165], v[0:1], v[0:1]
  v_pk_mul_f32 v[166:167], v[2:3], v[2:3]
  v_pk_fma_f32 v[164:165], v[164:165], v[196:197], v[196:197] op_sel:[0,1,0] op_sel_hi:[1,1,0]
  v_pk_fma_f32 v[166:167], v[166:167], v[196:197], v[196:197] op_sel:[0,1,0] op_sel_hi:[1,1,0]
  v_pk_mul_f32 v[164:165], v[164:165], v[0:1]
  v_pk_mul_f32 v[166:167], v[166:167], v[2:3]
  v_exp_f32 v164, v164
  v_exp_f32 v165, v165
  v_exp_f32 v166, v166
  v_exp_f32 v167, v167
  v_pk_mul_f32 v[28:29], v[28:29], v[0:1]
  v_pk_mul_f32 v[30:31], v[30:31], v[2:3]
  v_pk_fma_f32 v[164:165], v[164:165], v[194:195], v[194:195] op_sel_hi:[1,0,0]
  v_pk_fma_f32 v[166:167], v[166:167], v[194:195], v[194:195] op_sel_hi:[1,0,0]
  v_rcp_f32 v164, v164
  v_rcp_f32 v165, v165
  v_rcp_f32 v166, v166
  v_rcp_f32 v167, v167
  s_nop 0
  v_pk_mul_f32 v[28:29], v[28:29], v[164:165]
  v_pk_mul_f32 v[30:31], v[30:31], v[166:167]
  v_cvt_pk_bf16_f32 v2, v28, v29
  v_cvt_pk_bf16_f32 v3, v30, v31
  s_nop 1
  v_permlane16_swap_b32 v0, v2
  v_permlane16_swap_b32 v1, v3
  s_mov_b32 exec_lo, 4294901760
  s_mov_b32 exec_hi, 4294901760
  buffer_store_dwordx4 v[0:3], v113, s[12:15], s21 offen offset:0 sc0 sc1
  s_mov_b64 exec, -1
  v_pk_fma_f32 v[56:57], v[200:201], v[132:133], v[56:57] op_sel_hi:[0,1,1]
  v_pk_fma_f32 v[58:59], v[200:201], v[134:135], v[58:59] op_sel_hi:[0,1,1]
  v_pk_fma_f32 v[84:85], v[200:201], v[136:137], v[84:85] op_sel_hi:[0,1,1]
  v_pk_fma_f32 v[86:87], v[200:201], v[138:139], v[86:87] op_sel_hi:[0,1,1]
  v_pk_mul_f32 v[56:57], v[56:57], v[200:201] op_sel:[0,1] op_sel_hi:[1,1]
  v_pk_mul_f32 v[58:59], v[58:59], v[200:201] op_sel:[0,1] op_sel_hi:[1,1]
  v_pk_mul_f32 v[164:165], v[56:57], v[56:57]
  v_pk_mul_f32 v[166:167], v[58:59], v[58:59]
  v_pk_fma_f32 v[164:165], v[164:165], v[196:197], v[196:197] op_sel:[0,1,0] op_sel_hi:[1,1,0]
  v_pk_fma_f32 v[166:167], v[166:167], v[196:197], v[196:197] op_sel:[0,1,0] op_sel_hi:[1,1,0]
  v_pk_mul_f32 v[164:165], v[164:165], v[56:57]
  v_pk_mul_f32 v[166:167], v[166:167], v[58:59]
  v_exp_f32 v164, v164
  v_exp_f32 v165, v165
  v_exp_f32 v166, v166
  v_exp_f32 v167, v167
  v_pk_mul_f32 v[84:85], v[84:85], v[56:57]
  v_pk_mul_f32 v[86:87], v[86:87], v[58:59]
  v_pk_fma_f32 v[164:165], v[164:165], v[202:203], v[202:203] op_sel_hi:[1,0,0]
  v_pk_fma_f32 v[166:167], v[166:167], v[202:203], v[202:203] op_sel_hi:[1,0,0]
  v_rcp_f32 v164, v164
  v_rcp_f32 v165, v165
  v_rcp_f32 v166, v166
  v_rcp_f32 v167, v167
  s_nop 0
  v_pk_mul_f32 v[84:85], v[84:85], v[164:165]
  v_pk_mul_f32 v[86:87], v[86:87], v[166:167]
  v_cvt_pk_bf16_f32 v58, v84, v85
  v_cvt_pk_bf16_f32 v59, v86, v87
  s_nop 1
  v_permlane16_swap_b32 v56, v58
  v_permlane16_swap_b32 v57, v59
  s_mov_b32 exec_lo, 4294901760
  s_mov_b32 exec_hi, 4294901760
  buffer_store_dwordx4 v[56:59], v113, s[12:15], s21 offen offset:1024 sc0 sc1
  s_mov_b64 exec, -1
  s_add_u32 s21, s21, 131072
  ds_read_b128 v[132:135], v115 offset:128
  ds_read_b128 v[136:139], v115 offset:640
  s_waitcnt lgkmcnt(2)
  v_pk_fma_f32 v[4:5], v[192:193], v[148:149], v[4:5] op_sel_hi:[0,1,1]
  v_pk_fma_f32 v[6:7], v[192:193], v[150:151], v[6:7] op_sel_hi:[0,1,1]
  v_pk_fma_f32 v[32:33], v[192:193], v[152:153], v[32:33] op_sel_hi:[0,1,1]
  v_pk_fma_f32 v[34:35], v[192:193], v[154:155], v[34:35] op_sel_hi:[0,1,1]
  v_pk_mul_f32 v[4:5], v[4:5], v[192:193] op_sel:[0,1] op_sel_hi:[1,1]
  v_pk_mul_f32 v[6:7], v[6:7], v[192:193] op_sel:[0,1] op_sel_hi:[1,1]
  v_pk_mul_f32 v[164:165], v[4:5], v[4:5]
  v_pk_mul_f32 v[166:167], v[6:7], v[6:7]
  v_pk_fma_f32 v[164:165], v[164:165], v[196:197], v[196:197] op_sel:[0,1,0] op_sel_hi:[1,1,0]
  v_pk_fma_f32 v[166:167], v[166:167], v[196:197], v[196:197] op_sel:[0,1,0] op_sel_hi:[1,1,0]
  v_pk_mul_f32 v[164:165], v[164:165], v[4:5]
  v_pk_mul_f32 v[166:167], v[166:167], v[6:7]
  v_exp_f32 v164, v164
  v_exp_f32 v165, v165
  v_exp_f32 v166, v166
  v_exp_f32 v167, v167
  v_pk_mul_f32 v[32:33], v[32:33], v[4:5]
  v_pk_mul_f32 v[34:35], v[34:35], v[6:7]
  v_pk_fma_f32 v[164:165], v[164:165], v[194:195], v[194:195] op_sel_hi:[1,0,0]
  v_pk_fma_f32 v[166:167], v[166:167], v[194:195], v[194:195] op_sel_hi:[1,0,0]
  v_rcp_f32 v164, v164
  v_rcp_f32 v165, v165
  v_rcp_f32 v166, v166
  v_rcp_f32 v167, v167
  s_nop 0
  v_pk_mul_f32 v[32:33], v[32:33], v[164:165]
  v_pk_mul_f32 v[34:35], v[34:35], v[166:167]
  v_cvt_pk_bf16_f32 v4, v32, v33
  v_cvt_pk_bf16_f32 v5, v34, v35
  v_pk_fma_f32 v[60:61], v[200:201], v[148:149], v[60:61] op_sel_hi:[0,1,1]
  v_pk_fma_f32 v[62:63], v[200:201], v[150:151], v[62:63] op_sel_hi:[0,1,1]
  v_pk_fma_f32 v[88:89], v[200:201], v[152:153], v[88:89] op_sel_hi:[0,1,1]
  v_pk_fma_f32 v[90:91], v[200:201], v[154:155], v[90:91] op_sel_hi:[0,1,1]
  v_pk_mul_f32 v[60:61], v[60:61], v[200:201] op_sel:[0,1] op_sel_hi:[1,1]
  v_pk_mul_f32 v[62:63], v[62:63], v[200:201] op_sel:[0,1] op_sel_hi:[1,1]
  v_pk_mul_f32 v[164:165], v[60:61], v[60:61]
  v_pk_mul_f32 v[166:167], v[62:63], v[62:63]
  v_pk_fma_f32 v[164:165], v[164:165], v[196:197], v[196:197] op_sel:[0,1,0] op_sel_hi:[1,1,0]
  v_pk_fma_f32 v[166:167], v[166:167], v[196:197], v[196:197] op_sel:[0,1,0] op_sel_hi:[1,1,0]
  v_pk_mul_f32 v[164:165], v[164:165], v[60:61]
  v_pk_mul_f32 v[166:167], v[166:167], v[62:63]
  v_exp_f32 v164, v164
  v_exp_f32 v165, v165
  v_exp_f32 v166, v166
  v_exp_f32 v167, v167
  v_pk_mul_f32 v[88:89], v[88:89], v[60:61]
  v_pk_mul_f32 v[90:91], v[90:91], v[62:63]
  v_pk_fma_f32 v[164:165], v[164:165], v[202:203], v[202:203] op_sel_hi:[1,0,0]
  v_pk_fma_f32 v[166:167], v[166:167], v[202:203], v[202:203] op_sel_hi:[1,0,0]
  v_rcp_f32 v164, v164
  v_rcp_f32 v165, v165
  v_rcp_f32 v166, v166
  v_rcp_f32 v167, v167
  s_nop 0
  v_pk_mul_f32 v[88:89], v[88:89], v[164:165]
  v_pk_mul_f32 v[90:91], v[90:91], v[166:167]
  v_cvt_pk_bf16_f32 v60, v88, v89
  v_cvt_pk_bf16_f32 v61, v90, v91
  ds_read_b128 v[148:151], v115 offset:192
  ds_read_b128 v[152:155], v115 offset:704
  s_waitcnt lgkmcnt(2)
  v_pk_fma_f32 v[8:9], v[192:193], v[132:133], v[8:9] op_sel_hi:[0,1,1]
  v_pk_fma_f32 v[10:11], v[192:193], v[134:135], v[10:11] op_sel_hi:[0,1,1]
  v_pk_fma_f32 v[36:37], v[192:193], v[136:137], v[36:37] op_sel_hi:[0,1,1]
  v_pk_fma_f32 v[38:39], v[192:193], v[138:139], v[38:39] op_sel_hi:[0,1,1]
  v_pk_mul_f32 v[8:9], v[8:9], v[192:193] op_sel:[0,1] op_sel_hi:[1,1]
  v_pk_mul_f32 v[10:11], v[10:11], v[192:193] op_sel:[0,1] op_sel_hi:[1,1]
  v_pk_mul_f32 v[164:165], v[8:9], v[8:9]
  v_pk_mul_f32 v[166:167], v[10:11], v[10:11]
  v_pk_fma_f32 v[164:165], v[164:165], v[196:197], v[196:197] op_sel:[0,1,0] op_sel_hi:[1,1,0]
  v_pk_fma_f32 v[166:167], v[166:167], v[196:197], v[196:197] op_sel:[0,1,0] op_sel_hi:[1,1,0]
  v_pk_mul_f32 v[164:165], v[164:165], v[8:9]
  v_pk_mul_f32 v[166:167], v[166:167], v[10:11]
  v_exp_f32 v164, v164
  v_exp_f32 v165, v165
  v_exp_f32 v166, v166
  v_exp_f32 v167, v167
  v_pk_mul_f32 v[36:37], v[36:37], v[8:9]
  v_pk_mul_f32 v[38:39], v[38:39], v[10:11]
  v_pk_fma_f32 v[164:165], v[164:165], v[194:195], v[194:195] op_sel_hi:[1,0,0]
  v_pk_fma_f32 v[166:167], v[166:167], v[194:195], v[194:195] op_sel_hi:[1,0,0]
  v_rcp_f32 v164, v164
  v_rcp_f32 v165, v165
  v_rcp_f32 v166, v166
  v_rcp_f32 v167, v167
  s_nop 0
  v_pk_mul_f32 v[36:37], v[36:37], v[164:165]
  v_pk_mul_f32 v[38:39], v[38:39], v[166:167]
  v_cvt_pk_bf16_f32 v6, v36, v37
  v_cvt_pk_bf16_f32 v7, v38, v39
  s_nop 1
  v_permlane16_swap_b32 v4, v6
  v_permlane16_swap_b32 v5, v7
  buffer_store_dwordx4 v[4:7], v113, s[12:15], s21 offen offset:0 sc0 sc1
  v_pk_fma_f32 v[64:65], v[200:201], v[132:133], v[64:65] op_sel_hi:[0,1,1]
  v_pk_fma_f32 v[66:67], v[200:201], v[134:135], v[66:67] op_sel_hi:[0,1,1]
  v_pk_fma_f32 v[92:93], v[200:201], v[136:137], v[92:93] op_sel_hi:[0,1,1]
  v_pk_fma_f32 v[94:95], v[200:201], v[138:139], v[94:95] op_sel_hi:[0,1,1]
  v_pk_mul_f32 v[64:65], v[64:65], v[200:201] op_sel:[0,1] op_sel_hi:[1,1]
  v_pk_mul_f32 v[66:67], v[66:67], v[200:201] op_sel:[0,1] op_sel_hi:[1,1]
  v_pk_mul_f32 v[164:165], v[64:65], v[64:65]
  v_pk_mul_f32 v[166:167], v[66:67], v[66:67]
  v_pk_fma_f32 v[164:165], v[164:165], v[196:197], v[196:197] op_sel:[0,1,0] op_sel_hi:[1,1,0]
  v_pk_fma_f32 v[166:167], v[166:167], v[196:197], v[196:197] op_sel:[0,1,0] op_sel_hi:[1,1,0]
  v_pk_mul_f32 v[164:165], v[164:165], v[64:65]
  v_pk_mul_f32 v[166:167], v[166:167], v[66:67]
  v_exp_f32 v164, v164
  v_exp_f32 v165, v165
  v_exp_f32 v166, v166
  v_exp_f32 v167, v167
  v_pk_mul_f32 v[92:93], v[92:93], v[64:65]
  v_pk_mul_f32 v[94:95], v[94:95], v[66:67]
  v_pk_fma_f32 v[164:165], v[164:165], v[202:203], v[202:203] op_sel_hi:[1,0,0]
  v_pk_fma_f32 v[166:167], v[166:167], v[202:203], v[202:203] op_sel_hi:[1,0,0]
  v_rcp_f32 v164, v164
  v_rcp_f32 v165, v165
  v_rcp_f32 v166, v166
  v_rcp_f32 v167, v167
  s_nop 0
  v_pk_mul_f32 v[92:93], v[92:93], v[164:165]
  v_pk_mul_f32 v[94:95], v[94:95], v[166:167]
  v_cvt_pk_bf16_f32 v62, v92, v93
  v_cvt_pk_bf16_f32 v63, v94, v95
  s_nop 1
  v_permlane16_swap_b32 v60, v62
  v_permlane16_swap_b32 v61, v63
  buffer_store_dwordx4 v[60:63], v113, s[12:15], s21 offen offset:1024 sc0 sc1
  s_add_u32 s21, s21, 131072
  ds_read_b128 v[132:135], v115 offset:256
  ds_read_b128 v[136:139], v115 offset:768
  s_waitcnt lgkmcnt(2)
  v_pk_fma_f32 v[12:13], v[192:193], v[148:149], v[12:13] op_sel_hi:[0,1,1]
  v_pk_fma_f32 v[14:15], v[192:193], v[150:151], v[14:15] op_sel_hi:[0,1,1]
  v_pk_fma_f32 v[40:41], v[192:193], v[152:153], v[40:41] op_sel_hi:[0,1,1]
  v_pk_fma_f32 v[42:43], v[192:193], v[154:155], v[42:43] op_sel_hi:[0,1,1]
  v_pk_mul_f32 v[12:13], v[12:13], v[192:193] op_sel:[0,1] op_sel_hi:[1,1]
  v_pk_mul_f32 v[14:15], v[14:15], v[192:193] op_sel:[0,1] op_sel_hi:[1,1]
  v_pk_mul_f32 v[164:165], v[12:13], v[12:13]
  v_pk_mul_f32 v[166:167], v[14:15], v[14:15]
  v_pk_fma_f32 v[164:165], v[164:165], v[196:197], v[196:197] op_sel:[0,1,0] op_sel_hi:[1,1,0]
  v_pk_fma_f32 v[166:167], v[166:167], v[196:197], v[196:197] op_sel:[0,1,0] op_sel_hi:[1,1,0]
  v_pk_mul_f32 v[164:165], v[164:165], v[12:13]
  v_pk_mul_f32 v[166:167], v[166:167], v[14:15]
  v_exp_f32 v164, v164
  v_exp_f32 v165, v165
  v_exp_f32 v166, v166
  v_exp_f32 v167, v167
  v_pk_mul_f32 v[40:41], v[40:41], v[12:13]
  v_pk_mul_f32 v[42:43], v[42:43], v[14:15]
  v_pk_fma_f32 v[164:165], v[164:165], v[194:195], v[194:195] op_sel_hi:[1,0,0]
  v_pk_fma_f32 v[166:167], v[166:167], v[194:195], v[194:195] op_sel_hi:[1,0,0]
  v_rcp_f32 v164, v164
  v_rcp_f32 v165, v165
  v_rcp_f32 v166, v166
  v_rcp_f32 v167, v167
  s_nop 0
  v_pk_mul_f32 v[40:41], v[40:41], v[164:165]
  v_pk_mul_f32 v[42:43], v[42:43], v[166:167]
  v_cvt_pk_bf16_f32 v12, v40, v41
  v_cvt_pk_bf16_f32 v13, v42, v43
  v_pk_fma_f32 v[68:69], v[200:201], v[148:149], v[68:69] op_sel_hi:[0,1,1]
  v_pk_fma_f32 v[70:71], v[200:201], v[150:151], v[70:71] op_sel_hi:[0,1,1]
  v_pk_fma_f32 v[96:97], v[200:201], v[152:153], v[96:97] op_sel_hi:[0,1,1]
  v_pk_fma_f32 v[98:99], v[200:201], v[154:155], v[98:99] op_sel_hi:[0,1,1]
  v_pk_mul_f32 v[68:69], v[68:69], v[200:201] op_sel:[0,1] op_sel_hi:[1,1]
  v_pk_mul_f32 v[70:71], v[70:71], v[200:201] op_sel:[0,1] op_sel_hi:[1,1]
  v_pk_mul_f32 v[164:165], v[68:69], v[68:69]
  v_pk_mul_f32 v[166:167], v[70:71], v[70:71]
  v_pk_fma_f32 v[164:165], v[164:165], v[196:197], v[196:197] op_sel:[0,1,0] op_sel_hi:[1,1,0]
  v_pk_fma_f32 v[166:167], v[166:167], v[196:197], v[196:197] op_sel:[0,1,0] op_sel_hi:[1,1,0]
  v_pk_mul_f32 v[164:165], v[164:165], v[68:69]
  v_pk_mul_f32 v[166:167], v[166:167], v[70:71]
  v_exp_f32 v164, v164
  v_exp_f32 v165, v165
  v_exp_f32 v166, v166
  v_exp_f32 v167, v167
  v_pk_mul_f32 v[96:97], v[96:97], v[68:69]
  v_pk_mul_f32 v[98:99], v[98:99], v[70:71]
  v_pk_fma_f32 v[164:165], v[164:165], v[202:203], v[202:203] op_sel_hi:[1,0,0]
  v_pk_fma_f32 v[166:167], v[166:167], v[202:203], v[202:203] op_sel_hi:[1,0,0]
  v_rcp_f32 v164, v164
  v_rcp_f32 v165, v165
  v_rcp_f32 v166, v166
  v_rcp_f32 v167, v167
  s_nop 0
  v_pk_mul_f32 v[96:97], v[96:97], v[164:165]
  v_pk_mul_f32 v[98:99], v[98:99], v[166:167]
  v_cvt_pk_bf16_f32 v68, v96, v97
  v_cvt_pk_bf16_f32 v69, v98, v99
  ds_read_b128 v[148:151], v115 offset:320
  ds_read_b128 v[152:155], v115 offset:832
  s_waitcnt lgkmcnt(2)
  v_pk_fma_f32 v[16:17], v[192:193], v[132:133], v[16:17] op_sel_hi:[0,1,1]
  v_pk_fma_f32 v[18:19], v[192:193], v[134:135], v[18:19] op_sel_hi:[0,1,1]
  v_pk_fma_f32 v[44:45], v[192:193], v[136:137], v[44:45] op_sel_hi:[0,1,1]
  v_pk_fma_f32 v[46:47], v[192:193], v[138:139], v[46:47] op_sel_hi:[0,1,1]
  v_pk_mul_f32 v[16:17], v[16:17], v[192:193] op_sel:[0,1] op_sel_hi:[1,1]
  v_pk_mul_f32 v[18:19], v[18:19], v[192:193] op_sel:[0,1] op_sel_hi:[1,1]
  v_pk_mul_f32 v[164:165], v[16:17], v[16:17]
  v_pk_mul_f32 v[166:167], v[18:19], v[18:19]
  v_pk_fma_f32 v[164:165], v[164:165], v[196:197], v[196:197] op_sel:[0,1,0] op_sel_hi:[1,1,0]
  v_pk_fma_f32 v[166:167], v[166:167], v[196:197], v[196:197] op_sel:[0,1,0] op_sel_hi:[1,1,0]
  v_pk_mul_f32 v[164:165], v[164:165], v[16:17]
  v_pk_mul_f32 v[166:167], v[166:167], v[18:19]
  v_exp_f32 v164, v164
  v_exp_f32 v165, v165
  v_exp_f32 v166, v166
  v_exp_f32 v167, v167
  v_pk_mul_f32 v[44:45], v[44:45], v[16:17]
  v_pk_mul_f32 v[46:47], v[46:47], v[18:19]
  v_pk_fma_f32 v[164:165], v[164:165], v[194:195], v[194:195] op_sel_hi:[1,0,0]
  v_pk_fma_f32 v[166:167], v[166:167], v[194:195], v[194:195] op_sel_hi:[1,0,0]
  v_rcp_f32 v164, v164
  v_rcp_f32 v165, v165
  v_rcp_f32 v166, v166
  v_rcp_f32 v167, v167
  s_nop 0
  v_pk_mul_f32 v[44:45], v[44:45], v[164:165]
  v_pk_mul_f32 v[46:47], v[46:47], v[166:167]
  v_cvt_pk_bf16_f32 v14, v44, v45
  v_cvt_pk_bf16_f32 v15, v46, v47
  s_nop 1
  v_permlane16_swap_b32 v12, v14
  v_permlane16_swap_b32 v13, v15
  buffer_store_dwordx4 v[12:15], v113, s[12:15], s21 offen offset:0 sc0 sc1
  v_pk_fma_f32 v[72:73], v[200:201], v[132:133], v[72:73] op_sel_hi:[0,1,1]
  v_pk_fma_f32 v[74:75], v[200:201], v[134:135], v[74:75] op_sel_hi:[0,1,1]
  v_pk_fma_f32 v[100:101], v[200:201], v[136:137], v[100:101] op_sel_hi:[0,1,1]
  v_pk_fma_f32 v[102:103], v[200:201], v[138:139], v[102:103] op_sel_hi:[0,1,1]
  v_pk_mul_f32 v[72:73], v[72:73], v[200:201] op_sel:[0,1] op_sel_hi:[1,1]
  v_pk_mul_f32 v[74:75], v[74:75], v[200:201] op_sel:[0,1] op_sel_hi:[1,1]
  v_pk_mul_f32 v[164:165], v[72:73], v[72:73]
  v_pk_mul_f32 v[166:167], v[74:75], v[74:75]
  v_pk_fma_f32 v[164:165], v[164:165], v[196:197], v[196:197] op_sel:[0,1,0] op_sel_hi:[1,1,0]
  v_pk_fma_f32 v[166:167], v[166:167], v[196:197], v[196:197] op_sel:[0,1,0] op_sel_hi:[1,1,0]
  v_pk_mul_f32 v[164:165], v[164:165], v[72:73]
  v_pk_mul_f32 v[166:167], v[166:167], v[74:75]
  v_exp_f32 v164, v164
  v_exp_f32 v165, v165
  v_exp_f32 v166, v166
  v_exp_f32 v167, v167
  v_pk_mul_f32 v[100:101], v[100:101], v[72:73]
  v_pk_mul_f32 v[102:103], v[102:103], v[74:75]
  v_pk_fma_f32 v[164:165], v[164:165], v[202:203], v[202:203] op_sel_hi:[1,0,0]
  v_pk_fma_f32 v[166:167], v[166:167], v[202:203], v[202:203] op_sel_hi:[1,0,0]
  v_rcp_f32 v164, v164
  v_rcp_f32 v165, v165
  v_rcp_f32 v166, v166
  v_rcp_f32 v167, v167
  s_nop 0
  v_pk_mul_f32 v[100:101], v[100:101], v[164:165]
  v_pk_mul_f32 v[102:103], v[102:103], v[166:167]
  v_cvt_pk_bf16_f32 v70, v100, v101
  v_cvt_pk_bf16_f32 v71, v102, v103
  s_nop 1
  v_permlane16_swap_b32 v68, v70
  v_permlane16_swap_b32 v69, v71
  buffer_store_dwordx4 v[68:71], v113, s[12:15], s21 offen offset:1024 sc0 sc1
  s_add_u32 s21, s21, 131072
  ds_read_b128 v[132:135], v115 offset:384
  ds_read_b128 v[136:139], v115 offset:896
  s_waitcnt lgkmcnt(2)
  v_pk_fma_f32 v[20:21], v[192:193], v[148:149], v[20:21] op_sel_hi:[0,1,1]
  v_pk_fma_f32 v[22:23], v[192:193], v[150:151], v[22:23] op_sel_hi:[0,1,1]
  v_pk_fma_f32 v[48:49], v[192:193], v[152:153], v[48:49] op_sel_hi:[0,1,1]
  v_pk_fma_f32 v[50:51], v[192:193], v[154:155], v[50:51] op_sel_hi:[0,1,1]
  v_pk_mul_f32 v[20:21], v[20:21], v[192:193] op_sel:[0,1] op_sel_hi:[1,1]
  v_pk_mul_f32 v[22:23], v[22:23], v[192:193] op_sel:[0,1] op_sel_hi:[1,1]
  v_pk_mul_f32 v[164:165], v[20:21], v[20:21]
  v_pk_mul_f32 v[166:167], v[22:23], v[22:23]
  v_pk_fma_f32 v[164:165], v[164:165], v[196:197], v[196:197] op_sel:[0,1,0] op_sel_hi:[1,1,0]
  v_pk_fma_f32 v[166:167], v[166:167], v[196:197], v[196:197] op_sel:[0,1,0] op_sel_hi:[1,1,0]
  v_pk_mul_f32 v[164:165], v[164:165], v[20:21]
  v_pk_mul_f32 v[166:167], v[166:167], v[22:23]
  v_exp_f32 v164, v164
  v_exp_f32 v165, v165
  v_exp_f32 v166, v166
  v_exp_f32 v167, v167
  v_pk_mul_f32 v[48:49], v[48:49], v[20:21]
  v_pk_mul_f32 v[50:51], v[50:51], v[22:23]
  v_pk_fma_f32 v[164:165], v[164:165], v[194:195], v[194:195] op_sel_hi:[1,0,0]
  v_pk_fma_f32 v[166:167], v[166:167], v[194:195], v[194:195] op_sel_hi:[1,0,0]
  v_rcp_f32 v164, v164
  v_rcp_f32 v165, v165
  v_rcp_f32 v166, v166
  v_rcp_f32 v167, v167
  s_nop 0
  v_pk_mul_f32 v[48:49], v[48:49], v[164:165]
  v_pk_mul_f32 v[50:51], v[50:51], v[166:167]
  v_cvt_pk_bf16_f32 v20, v48, v49
  v_cvt_pk_bf16_f32 v21, v50, v51
  v_pk_fma_f32 v[76:77], v[200:201], v[148:149], v[76:77] op_sel_hi:[0,1,1]
  v_pk_fma_f32 v[78:79], v[200:201], v[150:151], v[78:79] op_sel_hi:[0,1,1]
  v_pk_fma_f32 v[104:105], v[200:201], v[152:153], v[104:105] op_sel_hi:[0,1,1]
  v_pk_fma_f32 v[106:107], v[200:201], v[154:155], v[106:107] op_sel_hi:[0,1,1]
  v_pk_mul_f32 v[76:77], v[76:77], v[200:201] op_sel:[0,1] op_sel_hi:[1,1]
  v_pk_mul_f32 v[78:79], v[78:79], v[200:201] op_sel:[0,1] op_sel_hi:[1,1]
  v_pk_mul_f32 v[164:165], v[76:77], v[76:77]
  v_pk_mul_f32 v[166:167], v[78:79], v[78:79]
  v_pk_fma_f32 v[164:165], v[164:165], v[196:197], v[196:197] op_sel:[0,1,0] op_sel_hi:[1,1,0]
  v_pk_fma_f32 v[166:167], v[166:167], v[196:197], v[196:197] op_sel:[0,1,0] op_sel_hi:[1,1,0]
  v_pk_mul_f32 v[164:165], v[164:165], v[76:77]
  v_pk_mul_f32 v[166:167], v[166:167], v[78:79]
  v_exp_f32 v164, v164
  v_exp_f32 v165, v165
  v_exp_f32 v166, v166
  v_exp_f32 v167, v167
  v_pk_mul_f32 v[104:105], v[104:105], v[76:77]
  v_pk_mul_f32 v[106:107], v[106:107], v[78:79]
  v_pk_fma_f32 v[164:165], v[164:165], v[202:203], v[202:203] op_sel_hi:[1,0,0]
  v_pk_fma_f32 v[166:167], v[166:167], v[202:203], v[202:203] op_sel_hi:[1,0,0]
  v_rcp_f32 v164, v164
  v_rcp_f32 v165, v165
  v_rcp_f32 v166, v166
  v_rcp_f32 v167, v167
  s_nop 0
  v_pk_mul_f32 v[104:105], v[104:105], v[164:165]
  v_pk_mul_f32 v[106:107], v[106:107], v[166:167]
  v_cvt_pk_bf16_f32 v76, v104, v105
  v_cvt_pk_bf16_f32 v77, v106, v107
  s_waitcnt lgkmcnt(0)
  v_pk_fma_f32 v[24:25], v[192:193], v[132:133], v[24:25] op_sel_hi:[0,1,1]
  v_pk_fma_f32 v[26:27], v[192:193], v[134:135], v[26:27] op_sel_hi:[0,1,1]
  v_pk_fma_f32 v[52:53], v[192:193], v[136:137], v[52:53] op_sel_hi:[0,1,1]
  v_pk_fma_f32 v[54:55], v[192:193], v[138:139], v[54:55] op_sel_hi:[0,1,1]
  v_pk_mul_f32 v[24:25], v[24:25], v[192:193] op_sel:[0,1] op_sel_hi:[1,1]
  v_pk_mul_f32 v[26:27], v[26:27], v[192:193] op_sel:[0,1] op_sel_hi:[1,1]
  v_pk_mul_f32 v[164:165], v[24:25], v[24:25]
  v_pk_mul_f32 v[166:167], v[26:27], v[26:27]
  v_pk_fma_f32 v[164:165], v[164:165], v[196:197], v[196:197] op_sel:[0,1,0] op_sel_hi:[1,1,0]
  v_pk_fma_f32 v[166:167], v[166:167], v[196:197], v[196:197] op_sel:[0,1,0] op_sel_hi:[1,1,0]
  v_pk_mul_f32 v[164:165], v[164:165], v[24:25]
  v_pk_mul_f32 v[166:167], v[166:167], v[26:27]
  v_exp_f32 v164, v164
  v_exp_f32 v165, v165
  v_exp_f32 v166, v166
  v_exp_f32 v167, v167
  v_pk_mul_f32 v[52:53], v[52:53], v[24:25]
  v_pk_mul_f32 v[54:55], v[54:55], v[26:27]
  v_pk_fma_f32 v[164:165], v[164:165], v[194:195], v[194:195] op_sel_hi:[1,0,0]
  v_pk_fma_f32 v[166:167], v[166:167], v[194:195], v[194:195] op_sel_hi:[1,0,0]
  v_rcp_f32 v164, v164
  v_rcp_f32 v165, v165
  v_rcp_f32 v166, v166
  v_rcp_f32 v167, v167
  s_nop 0
  v_pk_mul_f32 v[52:53], v[52:53], v[164:165]
  v_pk_mul_f32 v[54:55], v[54:55], v[166:167]
  v_cvt_pk_bf16_f32 v22, v52, v53
  v_cvt_pk_bf16_f32 v23, v54, v55
  s_nop 1
  v_permlane16_swap_b32 v20, v22
  v_permlane16_swap_b32 v21, v23
  buffer_store_dwordx4 v[20:23], v113, s[12:15], s21 offen offset:0 sc0 sc1
  v_pk_fma_f32 v[80:81], v[200:201], v[132:133], v[80:81] op_sel_hi:[0,1,1]
  v_pk_fma_f32 v[82:83], v[200:201], v[134:135], v[82:83] op_sel_hi:[0,1,1]
  v_pk_fma_f32 v[108:109], v[200:201], v[136:137], v[108:109] op_sel_hi:[0,1,1]
  v_pk_fma_f32 v[110:111], v[200:201], v[138:139], v[110:111] op_sel_hi:[0,1,1]
  v_pk_mul_f32 v[80:81], v[80:81], v[200:201] op_sel:[0,1] op_sel_hi:[1,1]
  v_pk_mul_f32 v[82:83], v[82:83], v[200:201] op_sel:[0,1] op_sel_hi:[1,1]
  v_pk_mul_f32 v[164:165], v[80:81], v[80:81]
  v_pk_mul_f32 v[166:167], v[82:83], v[82:83]
  v_pk_fma_f32 v[164:165], v[164:165], v[196:197], v[196:197] op_sel:[0,1,0] op_sel_hi:[1,1,0]
  v_pk_fma_f32 v[166:167], v[166:167], v[196:197], v[196:197] op_sel:[0,1,0] op_sel_hi:[1,1,0]
  v_pk_mul_f32 v[164:165], v[164:165], v[80:81]
  v_pk_mul_f32 v[166:167], v[166:167], v[82:83]
  v_exp_f32 v164, v164
  v_exp_f32 v165, v165
  v_exp_f32 v166, v166
  v_exp_f32 v167, v167
  v_pk_mul_f32 v[108:109], v[108:109], v[80:81]
  v_pk_mul_f32 v[110:111], v[110:111], v[82:83]
  v_pk_fma_f32 v[164:165], v[164:165], v[202:203], v[202:203] op_sel_hi:[1,0,0]
  v_pk_fma_f32 v[166:167], v[166:167], v[202:203], v[202:203] op_sel_hi:[1,0,0]
  v_rcp_f32 v164, v164
  v_rcp_f32 v165, v165
  v_rcp_f32 v166, v166
  v_rcp_f32 v167, v167
  s_nop 0
  v_pk_mul_f32 v[108:109], v[108:109], v[164:165]
  v_pk_mul_f32 v[110:111], v[110:111], v[166:167]
  v_cvt_pk_bf16_f32 v78, v108, v109
  v_cvt_pk_bf16_f32 v79, v110, v111
  s_nop 1
  v_permlane16_swap_b32 v76, v78
  v_permlane16_swap_b32 v77, v79
  buffer_store_dwordx4 v[76:79], v113, s[12:15], s21 offen offset:1024 sc0 sc1
  s_add_u32 s21, s21, 131072
L_gemm3_kernel_end:
  s_endpgm
.globl gemm4_kernel
.p2align 8
.type gemm4_kernel,@function
gemm4_kernel:
  s_cmp_ge_u32 s2, 256
  s_cbranch_scc1 L_gemm4_kernel_end
  s_load_dwordx16 s[64:79], s[0:1], 0
  s_load_dwordx4 s[80:83], s[0:1], 64
  v_lshrrev_b32 v35, 6, v0
  v_and_b32 v32, 63, v0
  s_nop 0
  v_readfirstlane_b32 s20, v35
  s_and_b32 s21, s2, 7
  s_lshr_b32 s22, s2, 3
  s_and_b32 s23, s21, 1
  s_lshr_b32 s24, s21, 1
  s_and_b32 s26, s22, 3
  s_lshr_b32 s25, s22, 2
  s_mul_i32 s23, s23, 8
  s_add_u32 s17, s23, s25
  s_mul_i32 s24, s24, 4
  s_add_u32 s16, s24, s26
  v_lshlrev_b32 v33, 4, v32
  v_lshrrev_b32 v35, 5, v32
  v_mul_u32_u24 v34, 2048, v35
  v_bfe_u32 v36, v32, 2, 3
  v_lshl_add_u32 v34, v36, 7, v34
  v_lshrrev_b32 v36, 1, v36
  v_lshl_add_u32 v34, v36, 5, v34
  v_and_b32 v35, 3, v32
  v_lshl_add_u32 v34, v35, 3, v34
  s_sub_u32 s19, s20, 4
  s_max_i32 s19, s19, 0
  s_min_i32 s19, s19, 3
  s_mul_i32 s27, s19, 2
  s_and_b32 s28, s17, 7
  s_mov_b32 s56, 2048
  s_cmp_eq_u32 s28, 3
  s_cselect_b32 s56, 128, s56
  s_lshl_b32 s57, s56, 6
  v_lshrrev_b32 v37, 4, v32
  v_bfe_u32 v36, v32, 1, 2
  v_xor_b32 v36, v36, v37
  v_lshrrev_b32 v35, 5, v32
  v_mul_u32_u24 v35, 16, v35
  v_bfe_u32 v37, v32, 3, 2
  v_add_u32 v35, v35, v37
  v_mul_u32_u24 v35, s56, v35
  v_lshl_add_u32 v35, v36, 5, v35
  v_and_b32 v37, 1, v32
  v_lshl_add_u32 v35, v37, 4, v35
  s_add_u32 s28, s27, 0
  s_mul_i32 s29, s28, 65536
  s_lshr_b32 s29, s29, 16
  s_mul_i32 s30, s29, 1
  s_sub_u32 s28, s28, s30
  s_lshr_b32 s30, s29, 2
  s_mul_i32 s30, s30, 32
  s_bfe_u32 s31, s29, 0x10001
  s_mul_i32 s31, s31, 8
  s_add_u32 s30, s30, s31
  s_and_b32 s31, s29, 1
  s_mul_i32 s31, s31, 4
  s_add_u32 s30, s30, s31
  s_mul_i32 s30, s30, s56
  s_mul_i32 s31, s28, 128
  s_add_u32 s30, s30, s31
  v_add_u32 v48, s30, v35
  s_add_u32 s28, s27, 1
  s_mul_i32 s29, s28, 65536
  s_lshr_b32 s29, s29, 16
  s_mul_i32 s30, s29, 1
  s_sub_u32 s28, s28, s30
  s_lshr_b32 s30, s29, 2
  s_mul_i32 s30, s30, 32
  s_bfe_u32 s31, s29, 0x10001
  s_mul_i32 s31, s31, 8
  s_add_u32 s30, s30, s31
  s_and_b32 s31, s29, 1
  s_mul_i32 s31, s31, 4
  s_add_u32 s30, s30, s31
  s_mul_i32 s30, s30, s56
  s_mul_i32 s31, s28, 128
  s_add_u32 s30, s30, s31
  v_add_u32 v49, s30, v35
  s_waitcnt lgkmcnt(0)
  s_add_u32 s8, s82, 25165824
  s_addc_u32 s9, s83, 0
  s_mov_b32 s10, 14680064
  s_mov_b32 s11, 0x20000
  s_add_u32 s28, s27, 0
  s_mov_b32 s40, s76
  s_mov_b32 s41, s77
  s_cmp_ge_u32 s28, 8
  s_cselect_b32 s42, 0, 7340032
  s_mov_b32 s43, 0x20000
  s_add_u32 s28, s82, 24117248
  s_addc_u32 s29, s83, 0
  s_cmp_eq_u32 s56, 128
  s_cselect_b32 s40, s28, s40
  s_cselect_b32 s41, s29, s41
  s_cselect_b32 s42, 917504, s42
  s_mul_i32 s32, s16, 8
  s_mul_i32 s28, s20, 2
  s_add_u32 s18, s32, s28
  s_lshl_b32 s32, s18, 10
  s_mul_i32 s33, s17, 128
  s_lshr_b32 s28, s17, 3
  s_mul_i32 s28, s28, 458752
  s_cmp_eq_u32 s56, 128
  s_cselect_b32 s33, s28, s33
  s_lshl_b32 s39, s27, 10
  s_mov_b32 s37, 0
  s_mov_b32 s35, 0
  s_mov_b32 s38, 0x7ff00000
  s_cmp_lt_u32 s20, 4
  s_cbranch_scc1 L_gemm4_kernel_comp
  s_add_u32 s36, s37, s39
  s_add_u32 s37, s37, 8192
  s_cmp_eq_u32 s37, 49152
  s_cselect_b32 s37, 0, s37
  s_add_u32 m0, s36, 0
  s_nop 0
  buffer_load_dwordx4 v48, s[40:43], s33 offen lds
  s_add_u32 m0, s36, 1024
  s_nop 0
  buffer_load_dwordx4 v49, s[40:43], s33 offen lds
  s_add_u32 s33, s33, s57
  s_add_u32 s36, s37, s39
  s_add_u32 s37, s37, 8192
  s_cmp_eq_u32 s37, 49152
  s_cselect_b32 s37, 0, s37
  s_add_u32 m0, s36, 0
  s_nop 0
  buffer_load_dwordx4 v48, s[40:43], s33 offen lds
  s_add_u32 m0, s36, 1024
  s_nop 0
  buffer_load_dwordx4 v49, s[40:43], s33 offen lds
  s_add_u32 s33, s33, s57
  s_add_u32 s36, s37, s39
  s_add_u32 s37, s37, 8192
  s_cmp_eq_u32 s37, 49152
  s_cselect_b32 s37, 0, s37
  s_add_u32 m0, s36, 0
  s_nop 0
  buffer_load_dwordx4 v48, s[40:43], s33 offen lds
  s_add_u32 m0, s36, 1024
  s_nop 0
  buffer_load_dwordx4 v49, s[40:43], s33 offen lds
  s_add_u32 s33, s33, s57
  s_add_u32 s36, s37, s39
  s_add_u32 s37, s37, 8192
  s_cmp_eq_u32 s37, 49152
  s_cselect_b32 s37, 0, s37
  s_add_u32 m0, s36, 0
  s_nop 0
  buffer_load_dwordx4 v48, s[40:43], s33 offen lds
  s_add_u32 m0, s36, 1024
  s_nop 0
  buffer_load_dwordx4 v49, s[40:43], s33 offen lds
  s_add_u32 s33, s33, s57
  s_waitcnt vmcnt(6)
  s_barrier
  s_add_u32 s36, s37, s39
  s_add_u32 s37, s37, 8192
  s_cmp_eq_u32 s37, 49152
  s_cselect_b32 s37, 0, s37
  s_add_u32 m0, s36, 0
  s_nop 0
  buffer_load_dwordx4 v48, s[40:43], s33 offen lds
  s_add_u32 m0, s36, 1024
  s_nop 0
  buffer_load_dwordx4 v49, s[40:43], s33 offen lds
  s_add_u32 s33, s33, s57
  s_mov_b32 s34, 51
L_gemm4_kernel_lloop:
  s_waitcnt vmcnt(6)
  s_barrier
  s_add_u32 s36, s37, s39
  s_add_u32 s37, s37, 8192
  s_cmp_eq_u32 s37, 49152
  s_cselect_b32 s37, 0, s37
  s_add_u32 m0, s36, 0
  s_nop 0
  buffer_load_dwordx4 v48, s[40:43], s33 offen lds
  s_add_u32 m0, s36, 1024
  s_nop 0
  buffer_load_dwordx4 v49, s[40:43], s33 offen lds
  s_add_u32 s33, s33, s57
  s_sub_u32 s34, s34, 1
  s_cmp_lg_u32 s34, 0
  s_cbranch_scc1 L_gemm4_kernel_lloop
  s_waitcnt vmcnt(6)
  s_barrier
  s_waitcnt vmcnt(4)
  s_barrier
  s_waitcnt vmcnt(2)
  s_barrier
  s_waitcnt vmcnt(0)
  s_barrier
  s_barrier
  s_waitcnt lgkmcnt(0)
  s_branch L_gemm4_kernel_end
L_gemm4_kernel_comp:
  buffer_load_dwordx4 v[108:111], v33, s[8:11], s38 offen offset:0
  buffer_load_dwordx4 v[112:115], v33, s[8:11], s38 offen offset:1024
  buffer_load_dwordx4 v[52:55], v33, s[8:11], s32 offen offset:0
  buffer_load_dwordx4 v[56:59], v33, s[8:11], s32 offen offset:1024
  s_add_u32 s32, s32, 131072
  buffer_load_dwordx4 v[60:63], v33, s[8:11], s32 offen offset:0
  buffer_load_dwordx4 v[64:67], v33, s[8:11], s32 offen offset:1024
  s_add_u32 s32, s32, 131072
  buffer_load_dwordx4 v[68:71], v33, s[8:11], s32 offen offset:0
  buffer_load_dwordx4 v[72:75], v33, s[8:11], s32 offen offset:1024
  s_add_u32 s32, s32, 131072
  buffer_load_dwordx4 v[76:79], v33, s[8:11], s32 offen offset:0
  buffer_load_dwordx4 v[80:83], v33, s[8:11], s32 offen offset:1024
  s_add_u32 s32, s32, 131072
  buffer_load_dwordx4 v[84:87], v33, s[8:11], s32 offen offset:0
  buffer_load_dwordx4 v[88:91], v33, s[8:11], s32 offen offset:1024
  s_add_u32 s32, s32, 131072
  buffer_load_dwordx4 v[92:95], v33, s[8:11], s32 offen offset:0
  v_mov_b32 v0, 0
  v_mov_b32 v1, 0
  v_mov_b32 v2, 0
  v_mov_b32 v3, 0
  v_mov_b32 v4, 0
  v_mov_b32 v5, 0
  v_mov_b32 v6, 0
  v_mov_b32 v7, 0
  v_mov_b32 v8, 0
  v_mov_b32 v9, 0
  v_mov_b32 v10, 0
  v_mov_b32 v11, 0
  v_mov_b32 v12, 0
  v_mov_b32 v13, 0
  v_mov_b32 v14, 0
  v_mov_b32 v15, 0
  v_mov_b32 v16, 0
  v_mov_b32 v17, 0
  v_mov_b32 v18, 0
  v_mov_b32 v19, 0
  v_mov_b32 v20, 0
  v_mov_b32 v21, 0
  v_mov_b32 v22, 0
  v_mov_b32 v23, 0
  v_mov_b32 v24, 0
  v_mov_b32 v25, 0
  v_mov_b32 v26, 0
  v_mov_b32 v27, 0
  v_mov_b32 v28, 0
  v_mov_b32 v29, 0
  v_mov_b32 v30, 0
  v_mov_b32 v31, 0
  s_barrier
  v_add_u32 v40, s35, v34
  v_xor_b32 v41, 32, v40
  v_xor_b32 v42, 64, v40
  v_xor_b32 v43, 96, v40
  s_add_u32 s35, s35, 8192
  s_cmp_eq_u32 s35, 49152
  s_cselect_b32 s35, 0, s35
  ds_read_b64_tr_b16 v[116:117], v40 offset:0
  ds_read_b64_tr_b16 v[118:119], v40 offset:1024
  buffer_load_dwordx4 v[96:99], v33, s[8:11], s32 offen offset:1024
  s_add_u32 s32, s32, 131072
  ds_read_b64_tr_b16 v[120:121], v41 offset:0
  ds_read_b64_tr_b16 v[122:123], v41 offset:1024
  ds_read_b64_tr_b16 v[124:125], v42 offset:0
  ds_read_b64_tr_b16 v[126:127], v42 offset:1024
  buffer_load_dwordx4 v[100:103], v33, s[8:11], s32 offen offset:0
  ds_read_b64_tr_b16 v[128:129], v43 offset:0
  ds_read_b64_tr_b16 v[130:131], v43 offset:1024
  ds_read_b64_tr_b16 v[132:133], v40 offset:4096
  ds_read_b64_tr_b16 v[134:135], v40 offset:5120
  buffer_load_dwordx4 v[104:107], v33, s[8:11], s32 offen offset:1024
  s_add_u32 s32, s32, 131072
  ds_read_b64_tr_b16 v[136:137], v41 offset:4096
  ds_read_b64_tr_b16 v[138:139], v41 offset:5120
  s_mov_b32 s34, 14
L_gemm4_kernel_loop0:
  ds_read_b64_tr_b16 v[140:141], v42 offset:4096
  ds_read_b64_tr_b16 v[142:143], v42 offset:5120
  s_waitcnt vmcnt(12)
  s_waitcnt lgkmcnt(12)
  v_mfma_f32_16x16x32_bf16 v[0:3], v[116:119], v[52:55], v[0:3]
  buffer_load_dwordx4 v[108:111], v33, s[8:11], s32 offen offset:0
  v_mfma_f32_16x16x32_bf16 v[16:19], v[116:119], v[56:59], v[16:19]
  ds_read_b64_tr_b16 v[144:145], v43 offset:4096
  ds_read_b64_tr_b16 v[146:147], v43 offset:5120
  s_waitcnt lgkmcnt(12)
  v_mfma_f32_16x16x32_bf16 v[4:7], v[120:123], v[52:55], v[4:7]
  v_mfma_f32_16x16x32_bf16 v[20:23], v[120:123], v[56:59], v[20:23]
  s_barrier
  v_add_u32 v44, s35, v34
  v_xor_b32 v45, 32, v44
  v_xor_b32 v46, 64, v44
  v_xor_b32 v47, 96, v44
  s_add_u32 s35, s35, 8192
  s_cmp_eq_u32 s35, 49152
  s_cselect_b32 s35, 0, s35
  s_cmp_lg_u32 s34, 2
  s_cbranch_scc1 L_gemm4_kernel_nl
  s_add_u32 s4, s82, 16777216
  s_addc_u32 s5, s83, 0
  s_mov_b32 s6, 4194304
  s_mov_b32 s7, 0x20000
  s_mul_i32 s3, s17, 256
  s_add_u32 s3, s3, s18
  s_lshl_b32 s3, s3, 10
  buffer_load_dwordx4 v[148:151], v33, s[4:7], s3 offen offset:0
  buffer_load_dwordx4 v[152:155], v33, s[4:7], s3 offen offset:1024
  s_add_u32 s3, s3, 131072
  buffer_load_dwordx4 v[156:159], v33, s[4:7], s3 offen offset:0
  buffer_load_dwordx4 v[160:163], v33, s[4:7], s3 offen offset:1024
  s_add_u32 s3, s3, 131072
L_gemm4_kernel_nl:
  ds_read_b64_tr_b16 v[116:117], v44 offset:0
  ds_read_b64_tr_b16 v[118:119], v44 offset:1024
  s_waitcnt lgkmcnt(12)
  v_mfma_f32_16x16x32_bf16 v[8:11], v[124:127], v[52:55], v[8:11]
  buffer_load_dwordx4 v[112:115], v33, s[8:11], s32 offen offset:1024
  s_add_u32 s32, s32, 131072
  v_mfma_f32_16x16x32_bf16 v[24:27], v[124:127], v[56:59], v[24:27]
  ds_read_b64_tr_b16 v[120:121], v45 offset:0
  ds_read_b64_tr_b16 v[122:123], v45 offset:1024
  s_waitcnt lgkmcnt(12)
  v_mfma_f32_16x16x32_bf16 v[12:15], v[128:131], v[52:55], v[12:15]
  v_mfma_f32_16x16x32_bf16 v[28:31], v[128:131], v[56:59], v[28:31]
  ds_read_b64_tr_b16 v[124:125], v46 offset:0
  ds_read_b64_tr_b16 v[126:127], v46 offset:1024
  s_waitcnt vmcnt(12)
  s_waitcnt lgkmcnt(12)
  v_mfma_f32_16x16x32_bf16 v[0:3], v[132:135], v[60:63], v[0:3]
  buffer_load_dwordx4 v[52:55], v33, s[8:11], s32 offen offset:0
  v_mfma_f32_16x16x32_bf16 v[16:19], v[132:135], v[64:67], v[16:19]
  ds_read_b64_tr_b16 v[128:129], v47 offset:0
  ds_read_b64_tr_b16 v[130:131], v47 offset:1024
  s_waitcnt lgkmcnt(12)
  v_mfma_f32_16x16x32_bf16 v[4:7], v[136:139], v[60:63], v[4:7]
  v_mfma_f32_16x16x32_bf16 v[20:23], v[136:139], v[64:67], v[20:23]
  ds_read_b64_tr_b16 v[132:133], v44 offset:4096
  ds_read_b64_tr_b16 v[134:135], v44 offset:5120
  s_waitcnt lgkmcnt(12)
  v_mfma_f32_16x16x32_bf16 v[8:11], v[140:143], v[60:63], v[8:11]
  buffer_load_dwordx4 v[56:59], v33, s[8:11], s32 offen offset:1024
  s_add_u32 s32, s32, 131072
  v_mfma_f32_16x16x32_bf16 v[24:27], v[140:143], v[64:67], v[24:27]
  ds_read_b64_tr_b16 v[136:137], v45 offset:4096
  ds_read_b64_tr_b16 v[138:139], v45 offset:5120
  s_waitcnt lgkmcnt(12)
  v_mfma_f32_16x16x32_bf16 v[12:15], v[144:147], v[60:63], v[12:15]
  v_mfma_f32_16x16x32_bf16 v[28:31], v[144:147], v[64:67], v[28:31]
  ds_read_b64_tr_b16 v[140:141], v46 offset:4096
  ds_read_b64_tr_b16 v[142:143], v46 offset:5120
  s_waitcnt vmcnt(12)
  s_waitcnt lgkmcnt(12)
  v_mfma_f32_16x16x32_bf16 v[0:3], v[116:119], v[68:71], v[0:3]
  buffer_load_dwordx4 v[60:63], v33, s[8:11], s32 offen offset:0
  v_mfma_f32_16x16x32_bf16 v[16:19], v[116:119], v[72:75], v[16:19]
  ds_read_b64_tr_b16 v[144:145], v47 offset:4096
  ds_read_b64_tr_b16 v[146:147], v47 offset:5120
  s_waitcnt lgkmcnt(12)
  v_mfma_f32_16x16x32_bf16 v[4:7], v[120:123], v[68:71], v[4:7]
  v_mfma_f32_16x16x32_bf16 v[20:23], v[120:123], v[72:75], v[20:23]
  s_barrier
  v_add_u32 v40, s35, v34
  v_xor_b32 v41, 32, v40
  v_xor_b32 v42, 64, v40
  v_xor_b32 v43, 96, v40
  s_add_u32 s35, s35, 8192
  s_cmp_eq_u32 s35, 49152
  s_cselect_b32 s35, 0, s35
  ds_read_b64_tr_b16 v[116:117], v40 offset:0
  ds_read_b64_tr_b16 v[118:119], v40 offset:1024
  s_waitcnt lgkmcnt(12)
  v_mfma_f32_16x16x32_bf16 v[8:11], v[124:127], v[68:71], v[8:11]
  buffer_load_dwordx4 v[64:67], v33, s[8:11], s32 offen offset:1024
  s_add_u32 s32, s32, 131072
  v_mfma_f32_16x16x32_bf16 v[24:27], v[124:127], v[72:75], v[24:27]
  ds_read_b64_tr_b16 v[120:121], v41 offset:0
  ds_read_b64_tr_b16 v[122:123], v41 offset:1024
  s_waitcnt lgkmcnt(12)
  v_mfma_f32_16x16x32_bf16 v[12:15], v[128:131], v[68:71], v[12:15]
  v_mfma_f32_16x16x32_bf16 v[28:31], v[128:131], v[72:75], v[28:31]
  ds_read_b64_tr_b16 v[124:125], v42 offset:0
  ds_read_b64_tr_b16 v[126:127], v42 offset:1024
  s_waitcnt vmcnt(12)
  s_waitcnt lgkmcnt(12)
  v_mfma_f32_16x16x32_bf16 v[0:3], v[132:135], v[76:79], v[0:3]
  buffer_load_dwordx4 v[68:71], v33, s[8:11], s32 offen offset:0
  v_mfma_f32_16x16x32_bf16 v[16:19], v[132:135], v[80:83], v[16:19]
  ds_read_b64_tr_b16 v[128:129], v43 offset:0
  ds_read_b64_tr_b16 v[130:131], v43 offset:1024
  s_waitcnt lgkmcnt(12)
  v_mfma_f32_16x16x32_bf16 v[4:7], v[136:139], v[76:79], v[4:7]
  v_mfma_f32_16x16x32_bf16 v[20:23], v[136:139], v[80:83], v[20:23]
  ds_read_b64_tr_b16 v[132:133], v40 offset:4096
  ds_read_b64_tr_b16 v[134:135], v40 offset:5120
  s_waitcnt lgkmcnt(12)
  v_mfma_f32_16x16x32_bf16 v[8:11], v[140:143], v[76:79], v[8:11]
  buffer_load_dwordx4 v[72:75], v33, s[8:11], s32 offen offset:1024
  s_add_u32 s32, s32, 131072
  v_mfma_f32_16x16x32_bf16 v[24:27], v[140:143], v[80:83], v[24:27]
  ds_read_b64_tr_b16 v[136:137], v41 offset:4096
  ds_read_b64_tr_b16 v[138:139], v41 offset:5120
  s_waitcnt lgkmcnt(12)
  v_mfma_f32_16x16x32_bf16 v[12:15], v[144:147], v[76:79], v[12:15]
  v_mfma_f32_16x16x32_bf16 v[28:31], v[144:147], v[80:83], v[28:31]
  ds_read_b64_tr_b16 v[140:141], v42 offset:4096
  ds_read_b64_tr_b16 v[142:143], v42 offset:5120
  s_waitcnt vmcnt(12)
  s_waitcnt lgkmcnt(12)
  v_mfma_f32_16x16x32_bf16 v[0:3], v[116:119], v[84:87], v[0:3]
  buffer_load_dwordx4 v[76:79], v33, s[8:11], s32 offen offset:0
  v_mfma_f32_16x16x32_bf16 v[16:19], v[116:119], v[88:91], v[16:19]
  ds_read_b64_tr_b16 v[144:145], v43 offset:4096
  ds_read_b64_tr_b16 v[146:147], v43 offset:5120
  s_waitcnt lgkmcnt(12)
  v_mfma_f32_16x16x32_bf16 v[4:7], v[120:123], v[84:87], v[4:7]
  v_mfma_f32_16x16x32_bf16 v[20:23], v[120:123], v[88:91], v[20:23]
  s_barrier
  v_add_u32 v44, s35, v34
  v_xor_b32 v45, 32, v44
  v_xor_b32 v46, 64, v44
  v_xor_b32 v47, 96, v44
  s_add_u32 s35, s35, 8192
  s_cmp_eq_u32 s35, 49152
  s_cselect_b32 s35, 0, s35
  ds_read_b64_tr_b16 v[116:117], v44 offset:0
  ds_read_b64_tr_b16 v[118:119], v44 offset:1024
  s_waitcnt lgkmcnt(12)
  v_mfma_f32_16x16x32_bf16 v[8:11], v[124:127], v[84:87], v[8:11]
  buffer_load_dwordx4 v[80:83], v33, s[8:11], s32 offen offset:1024
  s_add_u32 s32, s32, 131072
  v_mfma_f32_16x16x32_bf16 v[24:27], v[124:127], v[88:91], v[24:27]
  ds_read_b64_tr_b16 v[120:121], v45 offset:0
  ds_read_b64_tr_b16 v[122:123], v45 offset:1024
  s_waitcnt lgkmcnt(12)
  v_mfma_f32_16x16x32_bf16 v[12:15], v[128:131], v[84:87], v[12:15]
  v_mfma_f32_16x16x32_bf16 v[28:31], v[128:131], v[88:91], v[28:31]
  ds_read_b64_tr_b16 v[124:125], v46 offset:0
  ds_read_b64_tr_b16 v[126:127], v46 offset:1024
  s_waitcnt vmcnt(12)
  s_waitcnt lgkmcnt(12)
  v_mfma_f32_16x16x32_bf16 v[0:3], v[132:135], v[92:95], v[0:3]
  buffer_load_dwordx4 v[84:87], v33, s[8:11], s32 offen offset:0
  v_mfma_f32_16x16x32_bf16 v[16:19], v[132:135], v[96:99], v[16:19]
  ds_read_b64_tr_b16 v[128:129], v47 offset:0
  ds_read_b64_tr_b16 v[130:131], v47 offset:1024
  s_waitcnt lgkmcnt(12)
  v_mfma_f32_16x16x32_bf16 v[4:7], v[136:139], v[92:95], v[4:7]
  v_mfma_f32_16x16x32_bf16 v[20:23], v[136:139], v[96:99], v[20:23]
  ds_read_b64_tr_b16 v[132:133], v44 offset:4096
  ds_read_b64_tr_b16 v[134:135], v44 offset:5120
  s_waitcnt lgkmcnt(12)
  v_mfma_f32_16x16x32_bf16 v[8:11], v[140:143], v[92:95], v[8:11]
  buffer_load_dwordx4 v[88:91], v33, s[8:11], s32 offen offset:1024
  s_add_u32 s32, s32, 131072
  v_mfma_f32_16x16x32_bf16 v[24:27], v[140:143], v[96:99], v[24:27]
  ds_read_b64_tr_b16 v[136:137], v45 offset:4096
  ds_read_b64_tr_b16 v[138:139], v45 offset:5120
  s_waitcnt lgkmcnt(12)
  v_mfma_f32_16x16x32_bf16 v[12:15], v[144:147], v[92:95], v[12:15]
  v_mfma_f32_16x16x32_bf16 v[28:31], v[144:147], v[96:99], v[28:31]
  ds_read_b64_tr_b16 v[140:141], v46 offset:4096
  ds_read_b64_tr_b16 v[142:143], v46 offset:5120
  s_waitcnt vmcnt(12)
  s_waitcnt lgkmcnt(12)
  v_mfma_f32_16x16x32_bf16 v[0:3], v[116:119], v[100:103], v[0:3]
  buffer_load_dwordx4 v[92:95], v33, s[8:11], s32 offen offset:0
  v_mfma_f32_16x16x32_bf16 v[16:19], v[116:119], v[104:107], v[16:19]
  ds_read_b64_tr_b16 v[144:145], v47 offset:4096
  ds_read_b64_tr_b16 v[146:147], v47 offset:5120
  s_waitcnt lgkmcnt(12)
  v_mfma_f32_16x16x32_bf16 v[4:7], v[120:123], v[100:103], v[4:7]
  v_mfma_f32_16x16x32_bf16 v[20:23], v[120:123], v[104:107], v[20:23]
  s_barrier
  v_add_u32 v40, s35, v34
  v_xor_b32 v41, 32, v40
  v_xor_b32 v42, 64, v40
  v_xor_b32 v43, 96, v40
  s_add_u32 s35, s35, 8192
  s_cmp_eq_u32 s35, 49152
  s_cselect_b32 s35, 0, s35
  ds_read_b64_tr_b16 v[116:117], v40 offset:0
  ds_read_b64_tr_b16 v[118:119], v40 offset:1024
  s_waitcnt lgkmcnt(12)
  v_mfma_f32_16x16x32_bf16 v[8:11], v[124:127], v[100:103], v[8:11]
  buffer_load_dwordx4 v[96:99], v33, s[8:11], s32 offen offset:1024
  s_add_u32 s32, s32, 131072
  v_mfma_f32_16x16x32_bf16 v[24:27], v[124:127], v[104:107], v[24:27]
  ds_read_b64_tr_b16 v[120:121], v41 offset:0
  ds_read_b64_tr_b16 v[122:123], v41 offset:1024
  s_waitcnt lgkmcnt(12)
  v_mfma_f32_16x16x32_bf16 v[12:15], v[128:131], v[100:103], v[12:15]
  v_mfma_f32_16x16x32_bf16 v[28:31], v[128:131], v[104:107], v[28:31]
  ds_read_b64_tr_b16 v[124:125], v42 offset:0
  ds_read_b64_tr_b16 v[126:127], v42 offset:1024
  s_waitcnt vmcnt(12)
  s_waitcnt lgkmcnt(12)
  v_mfma_f32_16x16x32_bf16 v[0:3], v[132:135], v[108:111], v[0:3]
  buffer_load_dwordx4 v[100:103], v33, s[8:11], s32 offen offset:0
  v_mfma_f32_16x16x32_bf16 v[16:19], v[132:135], v[112:115], v[16:19]
  ds_read_b64_tr_b16 v[128:129], v43 offset:0
  ds_read_b64_tr_b16 v[130:131], v43 offset:1024
  s_waitcnt lgkmcnt(12)
  v_mfma_f32_16x16x32_bf16 v[4:7], v[136:139], v[108:111], v[4:7]
  v_mfma_f32_16x16x32_bf16 v[20:23], v[136:139], v[112:115], v[20:23]
  ds_read_b64_tr_b16 v[132:133], v40 offset:4096
  ds_read_b64_tr_b16 v[134:135], v40 offset:5120
  s_waitcnt lgkmcnt(12)
  v_mfma_f32_16x16x32_bf16 v[8:11], v[140:143], v[108:111], v[8:11]
  buffer_load_dwordx4 v[104:107], v33, s[8:11], s32 offen offset:1024
  s_add_u32 s32, s32, 131072
  v_mfma_f32_16x16x32_bf16 v[24:27], v[140:143], v[112:115], v[24:27]
  ds_read_b64_tr_b16 v[136:137], v41 offset:4096
  ds_read_b64_tr_b16 v[138:139], v41 offset:5120
  s_waitcnt lgkmcnt(12)
  v_mfma_f32_16x16x32_bf16 v[12:15], v[144:147], v[108:111], v[12:15]
  v_mfma_f32_16x16x32_bf16 v[28:31], v[144:147], v[112:115], v[28:31]
  s_sub_u32 s34, s34, 1
  s_cmp_lg_u32 s34, 0
  s_cbranch_scc1 L_gemm4_kernel_loop0
L_gemm4_kernel_join:
  s_waitcnt vmcnt(0) lgkmcnt(0)
  s_nop 7
  s_nop 7
  s_mov_b32 s12, s78
  s_mov_b32 s13, s79
  s_mov_b32 s14, 4194304
  s_mov_b32 s15, 0x20000
  v_and_b32 v52, 15, v32
  v_lshlrev_b32 v52, 11, v52
  v_bfe_u32 v53, v32, 4, 1
  v_lshl_add_u32 v52, v53, 5, v52
  v_bfe_u32 v53, v32, 5, 1
  v_lshl_add_u32 v52, v53, 4, v52
  s_lshl_b32 s21, s18, 15
  s_mul_i32 s22, s17, 128
  s_add_u32 s21, s21, s22
  s_waitcnt vmcnt(0)
  v_lshlrev_b32 v53, 16, v148
  v_and_b32 v54, 0xffff0000, v148
  v_add_f32 v0, v0, v53
  v_add_f32 v1, v1, v54
  v_lshlrev_b32 v53, 16, v149
  v_and_b32 v54, 0xffff0000, v149
  v_add_f32 v2, v2, v53
  v_add_f32 v3, v3, v54
  v_lshlrev_b32 v53, 16, v150
  v_and_b32 v54, 0xffff0000, v150
  v_add_f32 v4, v4, v53
  v_add_f32 v5, v5, v54
  v_lshlrev_b32 v53, 16, v151
  v_and_b32 v54, 0xffff0000, v151
  v_add_f32 v6, v6, v53
  v_add_f32 v7, v7, v54
  v_cvt_pk_bf16_f32 v0, v0, v1
  v_cvt_pk_bf16_f32 v1, v2, v3
  v_cvt_pk_bf16_f32 v2, v4, v5
  v_cvt_pk_bf16_f32 v3, v6, v7
  s_nop 1
  v_permlane16_swap_b32 v0, v2
  v_permlane16_swap_b32 v1, v3
  buffer_store_dwordx4 v[0:3], v52, s[12:15], s21 offen offset:0
  v_lshlrev_b32 v53, 16, v156
  v_and_b32 v54, 0xffff0000, v156
  v_add_f32 v8, v8, v53
  v_add_f32 v9, v9, v54
  v_lshlrev_b32 v53, 16, v157
  v_and_b32 v54, 0xffff0000, v157
  v_add_f32 v10, v10, v53
  v_add_f32 v11, v11, v54
  v_lshlrev_b32 v53, 16, v158
  v_and_b32 v54, 0xffff0000, v158
  v_add_f32 v12, v12, v53
  v_add_f32 v13, v13, v54
  v_lshlrev_b32 v53, 16, v159
  v_and_b32 v54, 0xffff0000, v159
  v_add_f32 v14, v14, v53
  v_add_f32 v15, v15, v54
  v_cvt_pk_bf16_f32 v8, v8, v9
  v_cvt_pk_bf16_f32 v9, v10, v11
  v_cvt_pk_bf16_f32 v10, v12, v13
  v_cvt_pk_bf16_f32 v11, v14, v15
  s_nop 1
  v_permlane16_swap_b32 v8, v10
  v_permlane16_swap_b32 v9, v11
  buffer_store_dwordx4 v[8:11], v52, s[12:15], s21 offen offset:64
  s_add_u32 s21, s21, 32768
  v_lshlrev_b32 v53, 16, v152
  v_and_b32 v54, 0xffff0000, v152
  v_add_f32 v16, v16, v53
  v_add_f32 v17, v17, v54
  v_lshlrev_b32 v53, 16, v153
  v_and_b32 v54, 0xffff0000, v153
  v_add_f32 v18, v18, v53
  v_add_f32 v19, v19, v54
  v_lshlrev_b32 v53, 16, v154
  v_and_b32 v54, 0xffff0000, v154
  v_add_f32 v20, v20, v53
  v_add_f32 v21, v21, v54
  v_lshlrev_b32 v53, 16, v155
  v_and_b32 v54, 0xffff0000, v155
  v_add_f32 v22, v22, v53
  v_add_f32 v23, v23, v54
  v_cvt_pk_bf16_f32 v16, v16, v17
  v_cvt_pk_bf16_f32 v17, v18, v19
  v_cvt_pk_bf16_f32 v18, v20, v21
  v_cvt_pk_bf16_f32 v19, v22, v23
  s_nop 1
  v_permlane16_swap_b32 v16, v18
  v_permlane16_swap_b32 v17, v19
  buffer_store_dwordx4 v[16:19], v52, s[12:15], s21 offen offset:0
  v_lshlrev_b32 v53, 16, v160
  v_and_b32 v54, 0xffff0000, v160
  v_add_f32 v24, v24, v53
  v_add_f32 v25, v25, v54
  v_lshlrev_b32 v53, 16, v161
  v_and_b32 v54, 0xffff0000, v161
  v_add_f32 v26, v26, v53
  v_add_f32 v27, v27, v54
  v_lshlrev_b32 v53, 16, v162
  v_and_b32 v54, 0xffff0000, v162
  v_add_f32 v28, v28, v53
  v_add_f32 v29, v29, v54
  v_lshlrev_b32 v53, 16, v163
  v_and_b32 v54, 0xffff0000, v163
  v_add_f32 v30, v30, v53
  v_add_f32 v31, v31, v54
  v_cvt_pk_bf16_f32 v24, v24, v25
  v_cvt_pk_bf16_f32 v25, v26, v27
  v_cvt_pk_bf16_f32 v26, v28, v29
  v_cvt_pk_bf16_f32 v27, v30, v31
  s_nop 1
  v_permlane16_swap_b32 v24, v26
  v_permlane16_swap_b32 v25, v27
  buffer_store_dwordx4 v[24:27], v52, s[12:15], s21 offen offset:64
  s_add_u32 s21, s21, 32768
L_gemm4_kernel_end:
  s_endpgm
L_text_end:
.section .rodata,"a"
.p2align 6
.amdhsa_kernel gemm1_kernel
  .amdhsa_next_free_vgpr 256
  .amdhsa_next_free_sgpr 100
  .amdhsa_accum_offset 256
  .amdhsa_group_segment_fixed_size 0
  .amdhsa_kernarg_size 80
  .amdhsa_user_sgpr_count 2
  .amdhsa_user_sgpr_kernarg_segment_ptr 1
  .amdhsa_system_sgpr_workgroup_id_x 1
.end_amdhsa_kernel
.amdhsa_kernel attn_kernel
  .amdhsa_next_free_vgpr 120
  .amdhsa_next_free_sgpr 100
  .amdhsa_accum_offset 120
  .amdhsa_group_segment_fixed_size 0
  .amdhsa_kernarg_size 80
  .amdhsa_user_sgpr_count 2
  .amdhsa_user_sgpr_kernarg_segment_ptr 1
  .amdhsa_system_sgpr_workgroup_id_x 1
.end_amdhsa_kernel
.amdhsa_kernel gemm2_kernel
  .amdhsa_next_free_vgpr 164
  .amdhsa_next_free_sgpr 100
  .amdhsa_accum_offset 164
  .amdhsa_group_segment_fixed_size 0
  .amdhsa_kernarg_size 80
  .amdhsa_user_sgpr_count 2
  .amdhsa_user_sgpr_kernarg_segment_ptr 1
  .amdhsa_system_sgpr_workgroup_id_x 1
.end_amdhsa_kernel
.amdhsa_kernel gemm3_kernel
  .amdhsa_next_free_vgpr 216
  .amdhsa_next_free_sgpr 100
  .amdhsa_accum_offset 216
  .amdhsa_group_segment_fixed_size 0
  .amdhsa_kernarg_size 80
  .amdhsa_user_sgpr_count 2
  .amdhsa_user_sgpr_kernarg_segment_ptr 1
  .amdhsa_system_sgpr_workgroup_id_x 1
.end_amdhsa_kernel
.amdhsa_kernel gemm4_kernel
  .amdhsa_next_free_vgpr 164
  .amdhsa_next_free_sgpr 100
  .amdhsa_accum_offset 164
  .amdhsa_group_segment_fixed_size 0
  .amdhsa_kernarg_size 80
  .amdhsa_user_sgpr_count 2
  .amdhsa_user_sgpr_kernarg_segment_ptr 1
  .amdhsa_system_sgpr_workgroup_id_x 1
.end_amdhsa_kernel
```
